```python
import torch

def _softmax(x, axis=-1):
    return torch.softmax(x, dim=axis)
def _gelu(x):
    return torch.nn.functional.gelu(x, approximate="tanh")
def _silu(x):
    return torch.nn.functional.silu(x)
def _sigmoid(x):
    return torch.sigmoid(x)
def _layernorm(x, axis=-1, eps=1e-5):
    m = x.mean(dim=axis, keepdim=True)
    v = x.var(dim=axis, keepdim=True, unbiased=False)
    return (x - m) / torch.sqrt(v + eps)
def _scatter_add(tgt, idx, src, axis=0):
    return tgt.clone().index_add_(axis, idx, src)
def _segment_sum(src, seg, n):
    out = torch.zeros((n,) + src.shape[1:], dtype=src.dtype)
    return out.index_add_(0, seg, src)
def _pad(x, pw):
    flat = tuple(v for pair in reversed(pw) for v in pair)
    return torch.nn.functional.pad(x, flat)

kernel_name = 'recurrent_scan__compressed_kv_cla__dense_activation_gelu__decode'

def setup_inputs():

    _w = (lambda a: (lambda t: t.to(torch.bfloat16) if t.is_floating_point() else t)(torch.as_tensor(a)))
    def _A_setup():
        B, H, Sq, Sk, D, M = 1, 32, 1, 8192, 192, 640
        Dc = 4 * D
        return {
            "x": _w((lambda *s: torch.randn(*s, dtype=torch.bfloat16) * 0.1)(B, Sq, M)),
            "c_kv": _w((lambda *s: torch.randn(*s, dtype=torch.bfloat16) * 3.2)(B, Sk, Dc)),
            "w_q": _w((lambda *s: torch.randn(*s, dtype=torch.bfloat16) * 0.8)(M, H, D) * (M ** -0.5)),
            "w_uk": _w((lambda *s: torch.randn(*s, dtype=torch.bfloat16) * 0.8)(Dc, H, D) * (Dc ** -0.5)),
            "w_uv": _w((lambda *s: torch.randn(*s, dtype=torch.bfloat16) * 3.2)(Dc, H, D) * (Dc ** -0.5)),
            "w_o": _w((lambda *s: torch.randn(*s, dtype=torch.bfloat16) * 3.2)(H, D, M) * ((H * D) ** -0.5)),
        }
    _A_in = _A_setup()

    def _B_setup():
        B, S, D, F = 1, 1, 640, 1536
        return {
            "x": _w((lambda *s: torch.randn(*s, dtype=torch.bfloat16) * 0.1)(B, S, D)),
            "w1": _w((lambda *s: torch.randn(*s, dtype=torch.bfloat16) * 3.2)(D, F) * (D ** -0.5)),
            "b1": _w((lambda *s: torch.randn(*s, dtype=torch.bfloat16) * 3.2)(F) * 0.01),
            "w2": _w((lambda *s: torch.randn(*s, dtype=torch.bfloat16) * 3.2)(F, D) * (F ** -0.5)),
            "b2": _w((lambda *s: torch.randn(*s, dtype=torch.bfloat16) * 3.2)(D) * 0.01),
        }
    _B_in = _B_setup()

    return {
        "A_x": _A_in["x"],
        "A_c_kv": _A_in["c_kv"],
        "A_w_q": _A_in["w_q"],
        "A_w_uk": _A_in["w_uk"],
        "A_w_uv": _A_in["w_uv"],
        "A_w_o": _A_in["w_o"],
        "B_x": _B_in["x"],
        "B_w1": _B_in["w1"],
        "B_b1": _B_in["b1"],
        "B_w2": _B_in["w2"],
        "B_b2": _B_in["b2"],
    }

def reference(A_x, A_c_kv, A_w_q, A_w_uk, A_w_uv, A_w_o, B_x, B_w1, B_b1, B_w2, B_b2):
    def _A_ref(x, c_kv, w_q, w_uk, w_uv, w_o):
        B, Sq, M = x.shape[0], x.shape[1], x.shape[2]
        Sk = c_kv.shape[1]
        H, D = w_q.shape[1], w_q.shape[2]
        q = torch.einsum("bqm,mhd->bhqd", x, w_q)
        k = torch.einsum("bkc,chd->bhkd", c_kv, w_uk)
        v = torch.einsum("bkc,chd->bhkd", c_kv, w_uv)
        scores = torch.einsum("bhqd,bhkd->bhqk", q, k) * (D ** -0.5)
        off = Sk - Sq
        qi = torch.arange(Sq)[:, None]
        kj = torch.arange(Sk)[None, :]
        cmask = kj <= (qi + off)
        scores = torch.where(cmask[None, None], scores, -1e9)
        p = _softmax(scores, axis=-1)
        ctx = torch.einsum("bhqk,bhkd->bhqd", p, v)
        return torch.einsum("bhqd,hdm->bqm", ctx, w_o)

    def _B_ref(x, w1, b1, w2, b2):
        h = torch.einsum("bsd,df->bsf", x, w1) + b1
        h = _gelu(h)
        return torch.einsum("bsf,fd->bsd", h, w2) + b2

    x = A_x
    xn = _layernorm(x, axis=-1)
    s = _A_ref(xn, A_c_kv, A_w_q, A_w_uk, A_w_uv, A_w_o)
    g = _silu(_B_ref(xn, B_w1, B_b1, B_w2, B_b2))
    return x + s * g
```

```asm
; @launch grid=(256,1,1) block=(512,1,1) lds=151808
.amdgcn_target "amdgcn-amd-amdhsa--gfx950"
.text
.globl recurrent_scan__compressed_kv_cla__dense_activation_gelu__decode_kernel
.p2align 8
.type recurrent_scan__compressed_kv_cla__dense_activation_gelu__decode_kernel,@function
recurrent_scan__compressed_kv_cla__dense_activation_gelu__decode_kernel:
    s_load_dwordx16 s[4:19], s[0:1], 0
    v_readfirstlane_b32 s34, v0
    s_cmp_ge_u32 s2, 256
    s_cbranch_scc1 L_end
    s_and_b32 s35, s2, 7
    s_lshr_b32 s36, s2, 3
    s_lshl_b32 s39, s35, 5
    s_or_b32 s39, s39, s36
    s_lshr_b32 s37, s39, 3
    s_and_b32 s38, s36, 7
    s_lshr_b32 s34, s34, 6
    s_cbranch_scc0 L_loader
    s_load_dwordx2 s[28:29], s[0:1], 104
    s_and_b32 s62, s2, 199
    s_xor_b32 s63, s34, 7
    s_or_b32 s40, s62, s63
    s_cbranch_scc0 L_qa
    s_cmp_lt_u32 s34, 4
    s_cbranch_scc1 L_z
L_nqa:
    s_getpc_b64 s[52:53]
L_pc:
    s_lshl2_add_u32 s54, s36, s34
    s_lshl_b32 s54, s54, 7
    s_min_u32 s54, s54, L_end-L_pc-64
    s_load_dword s56, s[52:53], s54
    s_add_u32 s54, s54, 64
    s_load_dword s57, s[52:53], s54
L_bar:
    s_load_dwordx8 s[20:27], s[0:1], 64
    s_barrier
    s_branch L_notloader
L_loader:
    v_lshrrev_b32 v15, 3, v0
    v_and_b32 v11, 6, v15
    v_xor_b32 v16, v11, v0
    v_and_b32 v16, 7, v16
    v_lshlrev_b32 v16, 4, v16
    v_mul_u32_u24 v7, 12288, v15
    v_add_u32 v6, v7, v16
    v_lshlrev_b32 v12, 4, v0
    s_mul_i32 s52, s38, 983040
    s_mul_i32 s53, s37, 384
    s_add_u32 s52, s52, s53
    s_mov_b32 m0, 137216
    s_mov_b32 s46, 7864320
    s_mov_b32 s47, 0x20000
    s_mov_b32 s51, 0x20000
    s_movk_i32 s50, 1280
    s_movk_i32 s56, 896
    s_movk_i32 s57, 1280
    s_waitcnt lgkmcnt(0)
    s_mov_b64 s[48:49], s[4:5]
    s_mov_b64 s[44:45], s[8:9]
    buffer_load_dwordx4 v12, s[48:51], 0 offen lds
    buffer_load_dwordx4 v12, s[48:51], 0 offen offset:1024 lds
    s_mov_b32 m0, 49152
    s_mov_b32 s55, 98304
    buffer_load_dwordx4 v6, s[44:47], s52 offen nt lds
    s_add_u32 m0, m0, s56
    s_nop 0
    buffer_load_dwordx4 v6, s[44:47], s52 offen offset:128 nt lds
    s_add_u32 m0, m0, s56
    s_nop 0
    buffer_load_dwordx4 v6, s[44:47], s52 offen offset:256 nt lds
    s_add_u32 m0, m0, s57
    s_add_u32 s52, s52, s55
    buffer_load_dwordx4 v6, s[44:47], s52 offen nt lds
    s_add_u32 m0, m0, s56
    s_nop 0
    buffer_load_dwordx4 v6, s[44:47], s52 offen offset:128 nt lds
    s_add_u32 m0, m0, s56
    s_nop 0
    buffer_load_dwordx4 v6, s[44:47], s52 offen offset:256 nt lds
    s_add_u32 m0, m0, s57
    s_add_u32 s52, s52, s55
    buffer_load_dwordx4 v6, s[44:47], s52 offen nt lds
    s_add_u32 m0, m0, s56
    s_nop 0
    buffer_load_dwordx4 v6, s[44:47], s52 offen offset:128 nt lds
    s_add_u32 m0, m0, s56
    s_nop 0
    buffer_load_dwordx4 v6, s[44:47], s52 offen offset:256 nt lds
    s_add_u32 m0, m0, s57
    s_add_u32 s52, s52, s55
    buffer_load_dwordx4 v6, s[44:47], s52 offen nt lds
    s_add_u32 m0, m0, s56
    s_nop 0
    buffer_load_dwordx4 v6, s[44:47], s52 offen offset:128 nt lds
    s_add_u32 m0, m0, s56
    s_nop 0
    buffer_load_dwordx4 v6, s[44:47], s52 offen offset:256 nt lds
    s_add_u32 m0, m0, s57
    s_add_u32 s52, s52, s55
    buffer_load_dwordx4 v6, s[44:47], s52 offen nt lds
    s_add_u32 m0, m0, s56
    s_nop 0
    buffer_load_dwordx4 v6, s[44:47], s52 offen offset:128 nt lds
    s_add_u32 m0, m0, s56
    s_nop 0
    buffer_load_dwordx4 v6, s[44:47], s52 offen offset:256 nt lds
    s_add_u32 m0, m0, s57
    s_add_u32 s52, s52, s55
    buffer_load_dwordx4 v6, s[44:47], s52 offen nt lds
    s_add_u32 m0, m0, s56
    s_nop 0
    buffer_load_dwordx4 v6, s[44:47], s52 offen offset:128 nt lds
    s_add_u32 m0, m0, s56
    s_nop 0
    buffer_load_dwordx4 v6, s[44:47], s52 offen offset:256 nt lds
    s_add_u32 m0, m0, s57
    s_add_u32 s52, s52, s55
    buffer_load_dwordx4 v6, s[44:47], s52 offen nt lds
    s_add_u32 m0, m0, s56
    s_nop 0
    buffer_load_dwordx4 v6, s[44:47], s52 offen offset:128 nt lds
    s_add_u32 m0, m0, s56
    s_nop 0
    buffer_load_dwordx4 v6, s[44:47], s52 offen offset:256 nt lds
    s_add_u32 m0, m0, s57
    s_add_u32 s52, s52, s55
    buffer_load_dwordx4 v6, s[44:47], s52 offen nt lds
    s_add_u32 m0, m0, s56
    s_nop 0
    buffer_load_dwordx4 v6, s[44:47], s52 offen offset:128 nt lds
    s_add_u32 m0, m0, s56
    s_nop 0
    buffer_load_dwordx4 v6, s[44:47], s52 offen offset:256 nt lds
    s_add_u32 m0, m0, s57
    s_add_u32 s52, s52, s55
    buffer_load_dwordx4 v6, s[44:47], s52 offen nt lds
    s_add_u32 m0, m0, s56
    s_nop 0
    buffer_load_dwordx4 v6, s[44:47], s52 offen offset:128 nt lds
    s_add_u32 m0, m0, s56
    s_nop 0
    buffer_load_dwordx4 v6, s[44:47], s52 offen offset:256 nt lds
    s_add_u32 m0, m0, s57
    s_add_u32 s52, s52, s55
    s_barrier
    buffer_load_dwordx4 v6, s[44:47], s52 offen nt lds
    s_add_u32 m0, m0, s56
    s_nop 0
    buffer_load_dwordx4 v6, s[44:47], s52 offen offset:128 nt lds
    s_add_u32 m0, m0, s56
    s_nop 0
    buffer_load_dwordx4 v6, s[44:47], s52 offen offset:256 nt lds
    s_branch L_ld2
L_qa:
    s_mov_b32 s30, 12582912
    s_mov_b32 s31, 0x20000
    v_mov_b64 v[24:25], -1
    v_mov_b64 v[26:27], -1
    v_and_b32 v28, 63, v0
    v_lshlrev_b32 v28, 4, v28
    s_lshr_b32 s58, s2, 3
    s_mul_i32 s58, s58, 3
    s_lshr_b32 s59, s58, 1
    s_mul_i32 s59, s59, 28672
    s_mul_i32 s54, s58, 2048
    s_add_u32 s54, s54, s59
    s_add_u32 s54, s54, 32768
    s_add_u32 s58, s58, 1
    s_lshr_b32 s59, s58, 1
    s_mul_i32 s59, s59, 28672
    s_mul_i32 s55, s58, 2048
    s_add_u32 s55, s55, s59
    s_add_u32 s55, s55, 32768
    s_add_u32 s58, s58, 1
    s_lshr_b32 s59, s58, 1
    s_mul_i32 s59, s59, 28672
    s_mul_i32 s56, s58, 2048
    s_add_u32 s56, s56, s59
    s_add_u32 s56, s56, 32768
    s_waitcnt lgkmcnt(0)
    buffer_store_dwordx4 v[24:27], v28, s[28:31], s54 offen offset:0 sc1
    buffer_store_dwordx4 v[24:27], v28, s[28:31], s54 offen offset:1024 sc1
    buffer_store_dwordx4 v[24:27], v28, s[28:31], s55 offen offset:0 sc1
    buffer_store_dwordx4 v[24:27], v28, s[28:31], s55 offen offset:1024 sc1
    buffer_store_dwordx4 v[24:27], v28, s[28:31], s56 offen offset:0 sc1
    buffer_store_dwordx4 v[24:27], v28, s[28:31], s56 offen offset:1024 sc1
    s_branch L_nqa
L_z:
    v_lshlrev_b32 v28, 4, v0
    v_add_u32 v28, 143616, v28
    v_mov_b64 v[24:25], 0
    v_mov_b64 v[26:27], 0
    ds_write_b128 v28, v[24:27] offset:0
    ds_write_b128 v28, v[24:27] offset:3072
    ds_write_b128 v28, v[24:27] offset:4096
    s_waitcnt lgkmcnt(0)
    s_load_dwordx2 s[32:33], s[28:29], 0
    s_branch L_bar
L_ld2:
    s_setprio 3
    s_load_dwordx8 s[20:27], s[0:1], 64
    s_mov_b32 s34, 4
    s_and_b32 s41, s37, 3
    s_lshl2_add_u32 s41, s38, s41
    s_sub_u32 s41, s41, 20
    v_lshlrev_b32 v1, 2, v0
    v_add_u32 v1, 144640, v1
    v_bfe_u32 v11, v0, 4, 1
    v_xor_b32 v11, v11, v0
    v_and_b32 v11, 7, v11
    v_lshl_add_u32 v7, v11, 4, v7
    s_mul_i32 s52, s38, 1179648
    s_add_u32 s52, s52, s53
    s_mov_b32 s54, s52
    s_mov_b32 s55, 0
    s_mov_b32 s44, s10
    s_mov_b32 s45, s11
    s_mov_b32 s46, 9437184
    s_mov_b32 m0, 100352
    s_movk_i32 s61, 94
    v_lshrrev_b32 v11, 5, v0
    v_lshlrev_b32 v11, 4, v11
    v_xor_b32 v13, v12, v11
    v_xor_b32 v14, 16, v12
    v_add_u32 v17, 0, v0
    v_mul_u32_u24 v18, 0x5556, v17
    v_lshrrev_b32 v18, 18, v18
    v_mul_u32_u24 v19, 12, v18
    v_sub_u32 v17, v17, v19
    v_lshrrev_b32 v19, 1, v18
    v_and_b32 v18, 1, v18
    v_lshl_add_u32 v18, v19, 5, v18
    v_and_b32 v19, 2, v19
    v_xor_b32 v17, v17, v19
    v_mul_u32_u24 v18, 1536, v18
    v_lshl_add_u32 v20, v17, 4, v18
    v_add_u32 v17, 64, v0
    v_mul_u32_u24 v18, 0x5556, v17
    v_lshrrev_b32 v18, 18, v18
    v_mul_u32_u24 v19, 12, v18
    v_sub_u32 v17, v17, v19
    v_lshrrev_b32 v19, 1, v18
    v_and_b32 v18, 1, v18
    v_lshl_add_u32 v18, v19, 5, v18
    v_and_b32 v19, 2, v19
    v_xor_b32 v17, v17, v19
    v_mul_u32_u24 v18, 1536, v18
    v_lshl_add_u32 v21, v17, 4, v18
    v_subrev_u32 v21, 1024, v21
    v_add_u32 v17, 128, v0
    v_mul_u32_u24 v18, 0x5556, v17
    v_lshrrev_b32 v18, 18, v18
    v_mul_u32_u24 v19, 12, v18
    v_sub_u32 v17, v17, v19
    v_lshrrev_b32 v19, 1, v18
    v_and_b32 v18, 1, v18
    v_lshl_add_u32 v18, v19, 5, v18
    v_and_b32 v19, 2, v19
    v_xor_b32 v17, v17, v19
    v_mul_u32_u24 v18, 1536, v18
    v_lshl_add_u32 v22, v17, 4, v18
    v_subrev_u32 v22, 2048, v22
    v_mul_u32_u24 v9, 1280, v15
    v_add_u32 v9, v9, v16
    v_mul_u32_u24 v8, 3072, v15
    v_add_u32 v8, v8, v16
    s_mov_b32 s48, s6
    s_mov_b32 s49, s7
    s_mov_b32 s50, 12582912
    s_mul_i32 s58, s37, 393216
    s_mul_i32 s42, s38, 49152
    s_add_u32 s42, s42, s58
    s_mul_i32 s53, s38, 192
    s_add_u32 s58, s58, s53
    s_mov_b32 s59, 0
    s_mov_b32 s60, 49152
    v_mov_b32 v23, 64
    s_waitcnt vmcnt(30) lgkmcnt(0)
    ds_max_u32 v1, v23 offset:0
SG_1:
    v_xor_b32 v11, s55, v7
    s_add_u32 s55, s55, 32
    s_and_b32 s55, s55, 0x60
    s_waitcnt vmcnt(18)
    s_sub_u32 s63, s61, 18
    v_mov_b32 v23, s63
    ds_max_u32 v1, v23 offset:0
    buffer_load_dwordx4 v11, s[44:47], s52 offen nt lds
    s_add_u32 m0, m0, s56
    s_add_u32 s61, s61, 3
    buffer_load_dwordx4 v11, s[44:47], s52 offen offset:128 nt lds
    s_add_u32 m0, m0, s56
    s_nop 0
    buffer_load_dwordx4 v11, s[44:47], s52 offen offset:256 nt lds
    s_add_u32 m0, m0, s57
    s_add_u32 s52, s52, 98304
    s_cmp_lg_u32 m0, 137216
    s_cbranch_scc1 SG_1
    s_mov_b32 s52, s42
WP_2:
    ds_read_b32 v3, v1 offset:3072
    s_getreg_b32 s63, hwreg(HW_REG_IB_STS)
    s_bfe_u32 s62, s63, 0x20016
    s_and_b32 s63, s63, 15
    s_lshl4_add_u32 s63, s62, s63
    s_sub_u32 s63, s61, s63
    v_mov_b32 v23, s63
    ds_max_u32 v1, v23 offset:0
    s_waitcnt lgkmcnt(1)
    v_cmp_gt_u32 vcc, 3, v3
    s_cbranch_vccnz WP_2
SA_3:
    v_xor_b32 v17, s55, v12
    v_xor_b32 v18, s55, v13
    v_xor_b32 v19, s55, v14
    s_mov_b32 m0, s59
    s_waitcnt vmcnt(24)
    s_sub_u32 s63, s61, 24
    v_mov_b32 v23, s63
    ds_max_u32 v1, v23 offset:0
    buffer_load_dwordx4 v17, s[48:51], s52 offen nt lds
    buffer_load_dwordx4 v18, s[48:51], s52 offen offset:1024 nt lds
    buffer_load_dwordx4 v19, s[48:51], s52 offen offset:2048 nt lds
    s_mov_b32 m0, s60
    s_add_u32 s61, s61, 6
    buffer_load_dwordx4 v20, s[48:51], s58 offen offset:0 nt lds
    buffer_load_dwordx4 v21, s[48:51], s58 offen offset:1024 nt lds
    buffer_load_dwordx4 v22, s[48:51], s58 offen offset:2048 nt lds
    s_add_u32 s55, s55, 32
    s_and_b32 s55, s55, 0xe0
    s_add_u32 s52, s52, 3072
    s_add_u32 s58, s58, 3072
    s_add_u32 s60, s60, 3200
    s_add_u32 s59, s59, 3072
    s_cmp_lg_u32 s59, 49152
    s_cbranch_scc1 SA_3
    s_mov_b32 s44, s12
    s_mov_b32 s45, s13
    s_mov_b32 m0, 100352
    s_cmp_lt_u32 s41, 10
    s_cbranch_scc0 L_noff
    s_mul_i32 s52, s41, 196608
    s_mul_i32 s53, s35, 384
    s_add_u32 s52, s52, s53
    s_mov_b32 s48, s18
    s_mov_b32 s49, s19
    s_mov_b32 s50, 1966080
WP_4:
    ds_read_b32 v3, v1 offset:4608
    s_getreg_b32 s63, hwreg(HW_REG_IB_STS)
    s_bfe_u32 s62, s63, 0x20016
    s_and_b32 s63, s63, 15
    s_lshl4_add_u32 s63, s62, s63
    s_sub_u32 s63, s61, s63
    v_mov_b32 v23, s63
    ds_max_u32 v1, v23 offset:0
    s_waitcnt lgkmcnt(1)
    v_cmp_gt_u32 vcc, 4, v3
    s_cbranch_vccnz WP_4
SG_5:
    s_waitcnt vmcnt(15)
    s_sub_u32 s63, s61, 15
    v_mov_b32 v23, s63
    ds_max_u32 v1, v23 offset:0
    buffer_load_dwordx4 v8, s[48:51], s52 offen nt lds
    s_add_u32 m0, m0, s56
    s_add_u32 s61, s61, 3
    buffer_load_dwordx4 v8, s[48:51], s52 offen offset:128 nt lds
    s_add_u32 m0, m0, s56
    s_nop 0
    buffer_load_dwordx4 v8, s[48:51], s52 offen offset:256 nt lds
    s_add_u32 m0, m0, s57
    s_add_u32 s52, s52, 24576
    s_cmp_lg_u32 m0, 124928
    s_cbranch_scc1 SG_5
    s_mul_i32 s52, s35, 245760
    s_lshl_b32 s53, s41, 7
    s_add_u32 s52, s52, s53
    s_mov_b32 s48, s22
    s_mov_b32 s49, s23
    s_mov_b32 s50, 1966080
    s_mov_b32 m0, 0
WP_6:
    ds_read_b32 v3, v1 offset:2816
    s_getreg_b32 s63, hwreg(HW_REG_IB_STS)
    s_bfe_u32 s62, s63, 0x20016
    s_and_b32 s63, s63, 15
    s_lshl4_add_u32 s63, s62, s63
    s_sub_u32 s63, s61, s63
    v_mov_b32 v23, s63
    ds_max_u32 v1, v23 offset:0
    s_waitcnt lgkmcnt(1)
    v_cmp_gt_u32 vcc, 4, v3
    s_cbranch_vccnz WP_6
SG_7:
    s_waitcnt vmcnt(15)
    s_sub_u32 s63, s61, 15
    v_mov_b32 v23, s63
    ds_max_u32 v1, v23 offset:0
    buffer_load_dwordx4 v6, s[44:47], s54 offen nt lds
    s_add_u32 m0, m0, s56
    s_add_u32 s61, s61, 3
    buffer_load_dwordx4 v6, s[44:47], s54 offen offset:128 nt lds
    s_add_u32 m0, m0, s56
    s_nop 0
    buffer_load_dwordx4 v6, s[44:47], s54 offen offset:256 nt lds
    s_add_u32 m0, m0, s57
    s_add_u32 s54, s54, 98304
    s_cmp_lg_u32 m0, 12288
    s_cbranch_scc1 SG_7
WP_8:
    ds_read_b32 v3, v1 offset:2304
    s_getreg_b32 s63, hwreg(HW_REG_IB_STS)
    s_bfe_u32 s62, s63, 0x20016
    s_and_b32 s63, s63, 15
    s_lshl4_add_u32 s63, s62, s63
    s_sub_u32 s63, s61, s63
    v_mov_b32 v23, s63
    ds_max_u32 v1, v23 offset:0
    s_waitcnt lgkmcnt(1)
    v_cmp_gt_u32 vcc, 4, v3
    s_cbranch_vccnz WP_8
SG_9:
    s_waitcnt vmcnt(9)
    s_sub_u32 s63, s61, 9
    v_mov_b32 v23, s63
    ds_max_u32 v1, v23 offset:0
    buffer_load_dwordx4 v6, s[44:47], s54 offen nt lds
    s_add_u32 m0, m0, s56
    s_add_u32 s61, s61, 3
    buffer_load_dwordx4 v6, s[44:47], s54 offen offset:128 nt lds
    s_add_u32 m0, m0, s56
    s_nop 0
    buffer_load_dwordx4 v6, s[44:47], s54 offen offset:256 nt lds
    s_add_u32 m0, m0, s57
    s_add_u32 s54, s54, 98304
    s_cmp_lg_u32 m0, 24576
    s_cbranch_scc1 SG_9
WP_10:
    ds_read_b32 v3, v1 offset:5888
    s_getreg_b32 s63, hwreg(HW_REG_IB_STS)
    s_bfe_u32 s62, s63, 0x20016
    s_and_b32 s63, s63, 15
    s_lshl4_add_u32 s63, s62, s63
    s_sub_u32 s63, s61, s63
    v_mov_b32 v23, s63
    ds_max_u32 v1, v23 offset:0
    s_waitcnt lgkmcnt(1)
    v_cmp_gt_u32 vcc, 4, v3
    s_cbranch_vccnz WP_10
SG_11:
    s_waitcnt vmcnt(21)
    s_sub_u32 s63, s61, 21
    v_mov_b32 v23, s63
    ds_max_u32 v1, v23 offset:0
    buffer_load_dwordx4 v6, s[44:47], s54 offen nt lds
    s_add_u32 m0, m0, s56
    s_add_u32 s61, s61, 3
    buffer_load_dwordx4 v6, s[44:47], s54 offen offset:128 nt lds
    s_add_u32 m0, m0, s56
    s_nop 0
    buffer_load_dwordx4 v6, s[44:47], s54 offen offset:256 nt lds
    s_add_u32 m0, m0, s57
    s_add_u32 s54, s54, 98304
    s_cmp_lg_u32 m0, 36864
    s_cbranch_scc1 SG_11
    s_mov_b32 m0, 49152
S2_12:
    s_waitcnt vmcnt(21)
    s_sub_u32 s63, s61, 21
    v_mov_b32 v23, s63
    ds_max_u32 v1, v23 offset:0
    buffer_load_dwordx4 v9, s[48:51], s52 offen nt lds
    s_add_u32 m0, m0, 2048
    s_add_u32 s52, s52, 10240
    buffer_load_dwordx4 v9, s[48:51], s52 offen nt lds
    s_add_u32 m0, m0, 2048
    s_add_u32 s52, s52, 10240
    buffer_load_dwordx4 v9, s[48:51], s52 offen nt lds
    s_add_u32 m0, m0, 2048
    s_add_u32 s52, s52, 10240
    s_add_u32 s61, s61, 3
    s_cmp_lg_u32 m0, 61440
    s_cbranch_scc1 S2_12
WP_13:
    ds_read_b32 v3, v1 offset:5120
    s_getreg_b32 s63, hwreg(HW_REG_IB_STS)
    s_bfe_u32 s62, s63, 0x20016
    s_and_b32 s63, s63, 15
    s_lshl4_add_u32 s63, s62, s63
    s_sub_u32 s63, s61, s63
    v_mov_b32 v23, s63
    ds_max_u32 v1, v23 offset:0
    s_waitcnt lgkmcnt(1)
    v_cmp_gt_u32 vcc, 1, v3
    s_cbranch_vccnz WP_13
S2_14:
    s_waitcnt vmcnt(21)
    s_sub_u32 s63, s61, 21
    v_mov_b32 v23, s63
    ds_max_u32 v1, v23 offset:0
    buffer_load_dwordx4 v9, s[48:51], s52 offen nt lds
    s_add_u32 m0, m0, 2048
    s_add_u32 s52, s52, 10240
    buffer_load_dwordx4 v9, s[48:51], s52 offen nt lds
    s_add_u32 m0, m0, 2048
    s_add_u32 s52, s52, 10240
    buffer_load_dwordx4 v9, s[48:51], s52 offen nt lds
    s_add_u32 m0, m0, 2048
    s_add_u32 s52, s52, 10240
    s_add_u32 s61, s61, 3
    s_cmp_lg_u32 m0, 98304
    s_cbranch_scc1 S2_14
    s_branch L_drain
L_noff:
    s_mul_i32 s52, s37, 245760
    s_lshl_b32 s53, s38, 8
    s_add_u32 s52, s52, s53
    s_mov_b32 s48, s14
    s_mov_b32 s49, s15
    s_mov_b32 s50, 7864320
WP_15:
    ds_read_b32 v3, v1 offset:4608
    s_getreg_b32 s63, hwreg(HW_REG_IB_STS)
    s_bfe_u32 s62, s63, 0x20016
    s_and_b32 s63, s63, 15
    s_lshl4_add_u32 s63, s62, s63
    s_sub_u32 s63, s61, s63
    v_mov_b32 v23, s63
    ds_max_u32 v1, v23 offset:0
    s_waitcnt lgkmcnt(1)
    v_cmp_gt_u32 vcc, 4, v3
    s_cbranch_vccnz WP_15
SG_16:
    s_waitcnt vmcnt(15)
    s_sub_u32 s63, s61, 15
    v_mov_b32 v23, s63
    ds_max_u32 v1, v23 offset:0
    buffer_load_dwordx4 v6, s[44:47], s54 offen nt lds
    s_add_u32 m0, m0, s56
    s_add_u32 s61, s61, 3
    buffer_load_dwordx4 v6, s[44:47], s54 offen offset:128 nt lds
    s_add_u32 m0, m0, s56
    s_nop 0
    buffer_load_dwordx4 v6, s[44:47], s54 offen offset:256 nt lds
    s_add_u32 m0, m0, s57
    s_add_u32 s54, s54, 98304
    s_cmp_lg_u32 m0, 137216
    s_cbranch_scc1 SG_16
    s_mov_b32 m0, 0
    s_cmp_lt_u32 s38, 5
    s_cbranch_scc0 L_drain
WP_17:
    ds_read_b32 v3, v1 offset:2304
    s_getreg_b32 s63, hwreg(HW_REG_IB_STS)
    s_bfe_u32 s62, s63, 0x20016
    s_and_b32 s63, s63, 15
    s_lshl4_add_u32 s63, s62, s63
    s_sub_u32 s63, s61, s63
    v_mov_b32 v23, s63
    ds_max_u32 v1, v23 offset:0
    s_waitcnt lgkmcnt(1)
    v_cmp_gt_u32 vcc, 4, v3
    s_cbranch_vccnz WP_17
SO_18:
    s_waitcnt vmcnt(9)
    s_sub_u32 s63, s61, 9
    v_mov_b32 v23, s63
    ds_max_u32 v1, v23 offset:0
    buffer_load_dwordx4 v9, s[48:51], s52 offen nt lds
    s_add_u32 m0, m0, s56
    s_add_u32 s61, s61, 3
    buffer_load_dwordx4 v9, s[48:51], s52 offen offset:128 nt lds
    s_add_u32 m0, m0, 1152
    s_add_u32 s52, s52, 10240
    buffer_load_dwordx4 v9, s[48:51], s52 offen nt lds
    s_add_u32 m0, m0, s56
    s_waitcnt vmcnt(9)
    s_sub_u32 s63, s61, 9
    v_mov_b32 v23, s63
    ds_max_u32 v1, v23 offset:0
    buffer_load_dwordx4 v9, s[48:51], s52 offen offset:128 nt lds
    s_add_u32 m0, m0, 1152
    s_add_u32 s52, s52, 10240
    s_add_u32 s61, s61, 3
    buffer_load_dwordx4 v9, s[48:51], s52 offen nt lds
    s_add_u32 m0, m0, s56
    s_nop 0
    buffer_load_dwordx4 v9, s[48:51], s52 offen offset:128 nt lds
    s_add_u32 m0, m0, 1152
    s_add_u32 s52, s52, 10240
    s_cmp_lg_u32 m0, 12288
    s_cbranch_scc1 SO_18
WP_19:
    ds_read_b32 v3, v1 offset:5888
    s_getreg_b32 s63, hwreg(HW_REG_IB_STS)
    s_bfe_u32 s62, s63, 0x20016
    s_and_b32 s63, s63, 15
    s_lshl4_add_u32 s63, s62, s63
    s_sub_u32 s63, s61, s63
    v_mov_b32 v23, s63
    ds_max_u32 v1, v23 offset:0
    s_waitcnt lgkmcnt(1)
    v_cmp_gt_u32 vcc, 4, v3
    s_cbranch_vccnz WP_19
SO_20:
    s_waitcnt vmcnt(21)
    s_sub_u32 s63, s61, 21
    v_mov_b32 v23, s63
    ds_max_u32 v1, v23 offset:0
    buffer_load_dwordx4 v9, s[48:51], s52 offen nt lds
    s_add_u32 m0, m0, s56
    s_add_u32 s61, s61, 3
    buffer_load_dwordx4 v9, s[48:51], s52 offen offset:128 nt lds
    s_add_u32 m0, m0, 1152
    s_add_u32 s52, s52, 10240
    buffer_load_dwordx4 v9, s[48:51], s52 offen nt lds
    s_add_u32 m0, m0, s56
    s_waitcnt vmcnt(21)
    s_sub_u32 s63, s61, 21
    v_mov_b32 v23, s63
    ds_max_u32 v1, v23 offset:0
    buffer_load_dwordx4 v9, s[48:51], s52 offen offset:128 nt lds
    s_add_u32 m0, m0, 1152
    s_add_u32 s52, s52, 10240
    s_add_u32 s61, s61, 3
    buffer_load_dwordx4 v9, s[48:51], s52 offen nt lds
    s_add_u32 m0, m0, s56
    s_nop 0
    buffer_load_dwordx4 v9, s[48:51], s52 offen offset:128 nt lds
    s_add_u32 m0, m0, 1152
    s_add_u32 s52, s52, 10240
    s_cmp_lg_u32 m0, 30720
    s_cbranch_scc1 SO_20
WP_21:
    ds_read_b32 v3, v1 offset:5120
    s_getreg_b32 s63, hwreg(HW_REG_IB_STS)
    s_bfe_u32 s62, s63, 0x20016
    s_and_b32 s63, s63, 15
    s_lshl4_add_u32 s63, s62, s63
    s_sub_u32 s63, s61, s63
    v_mov_b32 v23, s63
    ds_max_u32 v1, v23 offset:0
    s_waitcnt lgkmcnt(1)
    v_cmp_gt_u32 vcc, 1, v3
    s_cbranch_vccnz WP_21
SO_22:
    s_waitcnt vmcnt(21)
    s_sub_u32 s63, s61, 21
    v_mov_b32 v23, s63
    ds_max_u32 v1, v23 offset:0
    buffer_load_dwordx4 v9, s[48:51], s52 offen nt lds
    s_add_u32 m0, m0, s56
    s_add_u32 s61, s61, 3
    buffer_load_dwordx4 v9, s[48:51], s52 offen offset:128 nt lds
    s_add_u32 m0, m0, 1152
    s_add_u32 s52, s52, 10240
    buffer_load_dwordx4 v9, s[48:51], s52 offen nt lds
    s_add_u32 m0, m0, s56
    s_waitcnt vmcnt(21)
    s_sub_u32 s63, s61, 21
    v_mov_b32 v23, s63
    ds_max_u32 v1, v23 offset:0
    buffer_load_dwordx4 v9, s[48:51], s52 offen offset:128 nt lds
    s_add_u32 m0, m0, 1152
    s_add_u32 s52, s52, 10240
    s_add_u32 s61, s61, 3
    buffer_load_dwordx4 v9, s[48:51], s52 offen nt lds
    s_add_u32 m0, m0, s56
    s_nop 0
    buffer_load_dwordx4 v9, s[48:51], s52 offen offset:128 nt lds
    s_add_u32 m0, m0, 1152
    s_add_u32 s52, s52, 10240
    s_cmp_lg_u32 m0, 49152
    s_cbranch_scc1 SO_22
L_drain:
DR_23:
    s_getreg_b32 s63, hwreg(HW_REG_IB_STS)
    s_bfe_u32 s62, s63, 0x20016
    s_and_b32 s63, s63, 15
    s_lshl4_add_u32 s63, s62, s63
    s_sub_u32 s63, s61, s63
    v_mov_b32 v23, s63
    ds_max_u32 v1, v23 offset:0
    s_sub_u32 s63, s61, s63
    s_cmp_gt_u32 s63, 6
    s_cbranch_scc1 DR_23
    v_mov_b32 v10, s61
    s_waitcnt vmcnt(0)
    ds_write_b32 v1, v10 offset:0
    s_branch L_fin
L_notloader:
    s_xor_b32 s34, s34, 4
    v_and_b32 v0, 63, v0
    s_and_b32 s41, s37, 3
    s_lshl2_add_u32 s41, s38, s41
    s_sub_u32 s41, s41, 20
    v_lshlrev_b32 v1, 2, v0
    v_add_u32 v1, 144640, v1
    v_and_b32 v4, 15, v0
    v_lshrrev_b32 v5, 4, v0
    v_mov_b32 v2, 1
    s_mov_b32 s42, 400000
    s_mov_b32 s30, 12582912
    s_mov_b32 s31, 0x20000
    s_cmp_eq_u32 s34, 6
    s_cbranch_scc1 L_w6
    s_cmp_eq_u32 s34, 5
    s_cbranch_scc1 L_w5
    s_cmp_eq_u32 s34, 7
    s_cbranch_scc1 L_w7
    s_waitcnt lgkmcnt(0)
    s_load_dwordx2 s[32:33], s[28:29], 0
    s_and_b32 s52, s34, 1
    s_lshr_b32 s53, s34, 1
    s_mov_b32 s56, 65537
    s_mov_b32 s57, 65537
    s_mov_b32 s58, 131074
    s_mov_b32 s59, 131074
    s_mov_b32 s60, 262148
    s_mov_b32 s61, 262148
    s_mov_b32 s62, 524296
    s_mov_b32 s63, 524296
    v_bfe_u32 v3, v0, 2, 3
    v_lshlrev_b32 v202, 7, v3
    v_lshrrev_b32 v3, 1, v3
    v_lshl_add_u32 v202, v3, 5, v202
    v_and_b32 v3, 3, v0
    v_lshl_add_u32 v202, v3, 3, v202
    v_lshrrev_b32 v6, 5, v0
    s_lshl_b32 s54, s34, 10
    s_add_u32 s54, s54, 49152
    v_mul_u32_u24 v7, 3072, v6
    v_add3_u32 v180, v202, v7, s54
    v_xor_b32 v181, 32, v180
    v_xor_b32 v182, 64, v180
    v_xor_b32 v183, 96, v180
    s_lshl_b32 s54, s53, 10
    s_lshl_b32 s55, s52, 6
    v_lshlrev_b32 v7, 11, v6
    v_add3_u32 v200, v202, v7, s54
    v_xor_b32 v200, s55, v200
    v_xor_b32 v201, 32, v200
    v_lshlrev_b32 v184, 4, v5
    v_add_u32 v184, 141312, v184
    v_lshlrev_b32 v185, 6, v5
    v_lshl_add_u32 v185, v4, 4, v185
    v_lshlrev_b32 v192, 4, v0
    v_lshrrev_b32 v7, 1, v4
    v_lshlrev_b32 v208, 6, v7
    v_and_b32 v7, 1, v4
    v_lshl_add_u32 v208, v7, 4, v208
    v_and_b32 v7, 1, v5
    v_lshl_add_u32 v208, v7, 5, v208
    v_lshl_add_u32 v208, v6, 10, v208
    s_mul_i32 s54, s34, 12288
    s_add_u32 s54, s54, 100352
    v_lshrrev_b32 v7, 2, v4
    v_mul_u32_u24 v7, 3072, v7
    v_and_b32 v8, 3, v4
    v_lshl_add_u32 v7, v8, 7, v7
    v_lshrrev_b32 v8, 1, v4
    v_xor_b32 v8, v8, v5
    v_lshlrev_b32 v8, 4, v8
    v_add3_u32 v186, v7, v8, s54
    v_xor_b32 v187, 64, v186
    s_mul_i32 s54, s53, 768
    v_mul_u32_u24 v7, 1536, v4
    v_lshlrev_b32 v8, 1, v5
    v_xor_b32 v8, v4, v8
    v_lshlrev_b32 v8, 4, v8
    v_add3_u32 v188, v7, v8, s54
    v_xor_b32 v189, 16, v188
    v_xor_b32 v190, 128, v188
    v_xor_b32 v191, 144, v188
    v_bfe_u32 v7, v4, 3, 1
    v_mul_u32_u24 v7, 3200, v7
    v_bfe_u32 v8, v4, 2, 1
    v_mul_u32_u24 v8, 192, v8
    v_mul_u32_u24 v9, 768, v5
    v_add3_u32 v7, v7, v8, v9
    v_and_b32 v8, 3, v4
    v_lshl_add_u32 v7, v8, 3, v7
    v_add_u32 v7, 49152, v7
    v_and_b32 v9, 1, v5
    v_lshlrev_b32 v9, 5, v9
    s_lshl_b32 s54, s53, 6
    v_add3_u32 v193, v7, v9, s54
    v_xor_b32 v10, 32, v9
    v_add3_u32 v194, v7, v10, s54
    s_lshl_b32 s54, s53, 5
    v_xor_b32 v10, s54, v9
    v_add_u32 v10, 128, v10
    v_add_u32 v199, v7, v10
    v_mul_u32_u24 v7, 24064, v5
    v_lshl_add_u32 v195, v4, 4, v7
    v_lshlrev_b32 v205, 2, v4
    v_add_u32 v196, v205, v7
    v_lshrrev_b32 v7, 2, v0
    v_lshl_add_u32 v197, v8, 4, v7
    v_lshlrev_b32 v197, 2, v197
    v_mul_u32_u24 v7, 96256, v7
    v_lshl_add_u32 v198, v8, 4, v7
    s_lshl_b32 s54, s52, 11
    s_add_u32 s54, s54, 137216
    v_add_u32 v204, s54, v192
    s_mul_i32 s20, s39, 12032
    s_add_u32 s20, s20, 4194304
    s_lshl_b32 s55, s34, 8
    s_add_u32 s21, s20, s55
    s_add_u32 s4, s21, 11264
    s_add_u32 s16, s21, 11264
    s_lshl_b32 s22, s52, 10
    s_add_u32 s22, s22, 8192
    s_lshl_b32 s23, s52, 6
    s_add_u32 s23, s23, 10240
    s_add_u32 s9, s20, s22
    s_add_u32 s10, s20, s23
    s_mul_i32 s20, s37, 96256
    s_add_u32 s20, s20, 4194304
    s_add_u32 s11, s20, s22
    s_add_u32 s12, s11, 12032
    s_add_u32 s13, s20, s23
    s_add_u32 s14, s13, 12032
    s_lshr_b32 s20, s37, 4
    s_mul_i32 s20, s20, 24
    s_mul_i32 s55, s38, 3
    s_add_u32 s55, s55, s34
    s_add_u32 s20, s20, s55
    s_and_b32 s22, s20, 1
    s_lshl_b32 s22, s22, 10
    s_lshr_b32 s21, s20, 1
    s_lshr_b32 s55, s21, 1
    s_mul_i32 s55, s55, 28672
    s_mul_i32 s20, s21, 2048
    s_add_u32 s20, s20, s55
    s_add_u32 s20, s20, s22
    s_bfe_u32 s55, s37, 0x30001
    s_and_b32 s21, s37, 1
    s_lshl3_add_u32 s55, s21, s55
    s_lshl_b32 s55, s55, 6
    s_add_u32 s20, s20, s55
    s_add_u32 s5, s20, 32768
    s_lshl1_add_u32 s20, s52, s53
    s_mul_i32 s20, s20, 98304
    s_add_u32 s6, s20, 32768
    s_add_u32 s7, s20, 34816
    s_add_u32 s8, s20, 65536
    s_add_u32 s24, s20, 67584
    s_add_u32 s25, s20, 98304
    s_add_u32 s26, s20, 100352
    s_lshr_b32 s55, s38, 2
    s_mul_i32 s55, s55, 0
    s_mul_i32 s20, s38, 12032
    s_add_u32 s20, s20, s55
    s_mul_i32 s55, s52, 1540096
    s_add_u32 s20, s20, s55
    s_lshl_b32 s55, s53, 7
    s_add_u32 s20, s20, s55
    s_add_u32 s20, s20, 4194304
    s_and_b32 s55, s37, 24
    s_bfe_u32 s21, s37, 0x20001
    s_or_b32 s55, s55, s21
    s_and_b32 s21, s37, 1
    s_lshl2_add_u32 s55, s21, s55
    s_lshl_b32 s55, s55, 8
    s_add_u32 s15, s20, s55
    s_lshr_b32 s55, s37, 2
    s_mul_i32 s55, s55, 22528
    s_mul_i32 s54, s37, 2560
    s_add_u32 s54, s54, s55
    s_lshl_b32 s55, s38, 9
    s_add_u32 s54, s54, s55
    s_lshl_b32 s55, s34, 7
    s_add_u32 s54, s54, s55
    s_add_u32 s54, s54, 2097152
    s_movk_i32 s19, 286
    s_mov_b32 s48, 0x00800080
    s_mov_b32 s49, 0x437f0000
    s_lshl_b32 s55, s52, 8
    v_add_u32 v6, s55, v1
    s_lshl_b32 s55, s52, 9
    s_add_u32 s55, s55, 142592
    v_lshl_add_u32 v203, v0, 3, s55
    s_waitcnt lgkmcnt(0)
    s_add_u32 s32, s32, 0x7f4a7c10
    s_addc_u32 s33, s33, 0x9e3779b9
    s_or_b32 s32, s32, 15
    s_getreg_b32 s55, hwreg(HW_REG_XCC_ID, 0, 4)
    s_xor_b32 s55, s55, s32
    v_mov_b32 v178, s55
    v_mov_b32 v179, s33
    s_and_b32 s55, s32, 0xbfffbfff
    v_mov_b32 v215, s55
    v_mov_b32 v219, s55
    s_cmp_eq_u32 s34, 3
    s_cbranch_scc0 L_s1
    s_cmp_eq_u32 s40, 0
    s_cbranch_scc0 L_s3
    s_mul_i32 s55, s2, 16
    s_add_u32 s55, s55, 1024
    s_waitcnt vmcnt(0)
    v_mov_b32 v24, s32
    v_mov_b32 v25, s33
    s_mov_b64 exec, 15
    buffer_store_dwordx4 v[24:27], v192, s[28:31], s55 offen sc1
    s_mov_b64 exec, -1
    s_waitcnt vmcnt(0)
    s_branch L_s3
L_s1:
WF_24:
    ds_read_b32 v3, v1 offset:512
    s_waitcnt lgkmcnt(0)
    v_cmp_gt_u32 vcc, 1, v3
    s_cbranch_vccnz WF_24
    ds_read_b128 v[16:19], v184 offset:0
    ds_read_b128 v[20:23], v184 offset:64
    ds_read_b64 v[24:25], v184 offset:128
    v_mov_b64 v[26:27], 0
    v_mov_b64 v[74:75], 0
    v_mov_b64 v[86:87], 0
    v_mov_b64 v[98:99], 0
    v_mov_b64 v[110:111], 0
WF_25:
    ds_read_b32 v3, v1 offset:0
    s_waitcnt lgkmcnt(0)
    v_cmp_gt_u32 vcc, 88, v3
    s_cbranch_vccnz WF_25
    ds_read_b64_tr_b16 v[64:65], v180 offset:0
    ds_read_b64_tr_b16 v[66:67], v180 offset:6144
    ds_read_b64_tr_b16 v[68:69], v180 offset:12288
    ds_read_b64_tr_b16 v[70:71], v180 offset:18432
    ds_read_b64_tr_b16 v[76:77], v181 offset:0
    ds_read_b64_tr_b16 v[78:79], v181 offset:6144
    ds_read_b64_tr_b16 v[80:81], v181 offset:12288
    ds_read_b64_tr_b16 v[82:83], v181 offset:18432
    ds_read_b64_tr_b16 v[88:89], v182 offset:0
    ds_read_b64_tr_b16 v[90:91], v182 offset:6144
    ds_read_b64_tr_b16 v[92:93], v182 offset:12288
    ds_read_b64_tr_b16 v[94:95], v182 offset:18432
    ds_read_b64_tr_b16 v[100:101], v183 offset:0
    ds_read_b64_tr_b16 v[102:103], v183 offset:6144
    ds_read_b64_tr_b16 v[104:105], v183 offset:12288
    ds_read_b64_tr_b16 v[106:107], v183 offset:18432
    s_waitcnt lgkmcnt(12)
    v_mfma_f32_16x16x32_bf16 v[160:163], v[64:67], v[16:19], 0
    v_mfma_f32_16x16x32_bf16 v[160:163], v[68:71], v[20:23], v[160:163]
    s_waitcnt lgkmcnt(8)
    v_mfma_f32_16x16x32_bf16 v[164:167], v[76:79], v[16:19], 0
    v_mfma_f32_16x16x32_bf16 v[164:167], v[80:83], v[20:23], v[164:167]
    s_waitcnt lgkmcnt(4)
    v_mfma_f32_16x16x32_bf16 v[168:171], v[88:91], v[16:19], 0
    v_mfma_f32_16x16x32_bf16 v[168:171], v[92:95], v[20:23], v[168:171]
    s_waitcnt lgkmcnt(0)
    v_mfma_f32_16x16x32_bf16 v[172:175], v[100:103], v[16:19], 0
    v_mfma_f32_16x16x32_bf16 v[172:175], v[104:107], v[20:23], v[172:175]
W1_26:
    ds_read_b32 v3, v1 offset:0
    ds_read_b64_tr_b16 v[72:73], v180 offset:24576
    ds_read_b64_tr_b16 v[84:85], v181 offset:24576
    ds_read_b64_tr_b16 v[96:97], v182 offset:24576
    ds_read_b64_tr_b16 v[108:109], v183 offset:24576
    s_waitcnt lgkmcnt(0)
    v_cmp_gt_u32 vcc, 94, v3
    s_cbranch_vccnz W1_26
    v_mfma_f32_16x16x32_bf16 v[160:163], v[72:75], v[24:27], v[160:163]
    v_mfma_f32_16x16x32_bf16 v[164:167], v[84:87], v[24:27], v[164:167]
    v_mfma_f32_16x16x32_bf16 v[168:171], v[96:99], v[24:27], v[168:171]
    v_mfma_f32_16x16x32_bf16 v[172:175], v[108:111], v[24:27], v[172:175]
    s_mov_b64 exec, s[56:57]
    s_nop 3
    v_cvt_pk_bf16_f32 v176, v160, v161
    v_cvt_pk_bf16_f32 v177, v162, v163
    s_mov_b64 exec, s[58:59]
    v_cvt_pk_bf16_f32 v176, v164, v165
    v_cvt_pk_bf16_f32 v177, v166, v167
    s_mov_b64 exec, s[60:61]
    v_cvt_pk_bf16_f32 v176, v168, v169
    v_cvt_pk_bf16_f32 v177, v170, v171
    s_mov_b64 exec, s[62:63]
    v_cvt_pk_bf16_f32 v176, v172, v173
    v_cvt_pk_bf16_f32 v177, v174, v175
    s_mov_b32 exec_lo, 0x000f000f
    s_mov_b32 exec_hi, 0x000f000f
    buffer_store_dwordx4 v[176:179], v185, s[28:31], s4 offen offset:0
    s_mov_b64 exec, -1
    ds_add_u32 v1, v2 offset:3072
    s_mov_b32 s46, 51200
    s_movk_i32 s47, 262
    s_cmp_lt_u32 s41, 10
    s_cselect_b32 s46, -49152, s46
    s_cselect_b32 s47, 286, s47
    v_add_u32 v180, s46, v180
    v_add_u32 v181, s46, v181
    v_add_u32 v182, s46, v182
    v_add_u32 v183, s46, v183
    v_mov_b32 v178, s32
    v_xor_b32 v179, 1, v179
WF_27:
    ds_read_b32 v3, v1 offset:1024
    s_waitcnt lgkmcnt(0)
    v_cmp_gt_u32 vcc, 1, v3
    s_cbranch_vccnz WF_27
WF_28:
    ds_read_b32 v3, v1 offset:0
    s_waitcnt lgkmcnt(0)
    v_cmp_gt_u32 vcc, 130, v3
    s_cbranch_vccnz WF_28
    ds_read_b128 v[64:67], v186 offset:0
    ds_read_b128 v[68:71], v186 offset:512
    ds_read_b128 v[72:75], v187 offset:0
    ds_read_b128 v[76:79], v187 offset:512
    ds_read_b128 v[80:83], v186 offset:1024
    ds_read_b128 v[84:87], v186 offset:1536
    ds_read_b128 v[88:91], v187 offset:1024
    ds_read_b128 v[92:95], v187 offset:1536
    ds_read_b128 v[96:99], v186 offset:2048
    ds_read_b128 v[100:103], v186 offset:2560
    ds_read_b128 v[104:107], v187 offset:2048
    ds_read_b128 v[108:111], v187 offset:2560
V2_29:
    ds_read_b32 v3, v1 offset:768
    ds_read_b128 v[16:19], v184 offset:512
    ds_read_b128 v[20:23], v184 offset:576
    ds_read_b128 v[24:27], v184 offset:640
    ds_read_b128 v[28:31], v184 offset:704
    ds_read_b128 v[32:35], v184 offset:768
    ds_read_b128 v[36:39], v184 offset:832
    s_waitcnt lgkmcnt(6)
    v_cmp_gt_u32 vcc, 1, v3
    s_cbranch_vccnz V2_29
    s_waitcnt lgkmcnt(5)
    v_mfma_f32_16x16x32_bf16 v[160:163], v[64:67], v[16:19], 0
    v_mfma_f32_16x16x32_bf16 v[164:167], v[68:71], v[16:19], 0
    s_waitcnt lgkmcnt(4)
    v_mfma_f32_16x16x32_bf16 v[160:163], v[72:75], v[20:23], v[160:163]
    v_mfma_f32_16x16x32_bf16 v[164:167], v[76:79], v[20:23], v[164:167]
    s_waitcnt lgkmcnt(3)
    v_mfma_f32_16x16x32_bf16 v[160:163], v[80:83], v[24:27], v[160:163]
    v_mfma_f32_16x16x32_bf16 v[164:167], v[84:87], v[24:27], v[164:167]
    s_waitcnt lgkmcnt(2)
    v_mfma_f32_16x16x32_bf16 v[160:163], v[88:91], v[28:31], v[160:163]
    v_mfma_f32_16x16x32_bf16 v[164:167], v[92:95], v[28:31], v[164:167]
    s_waitcnt lgkmcnt(1)
    v_mfma_f32_16x16x32_bf16 v[160:163], v[96:99], v[32:35], v[160:163]
    v_mfma_f32_16x16x32_bf16 v[164:167], v[100:103], v[32:35], v[164:167]
    s_waitcnt lgkmcnt(0)
    v_mfma_f32_16x16x32_bf16 v[160:163], v[104:107], v[36:39], v[160:163]
    v_mfma_f32_16x16x32_bf16 v[164:167], v[108:111], v[36:39], v[164:167]
    v_readfirstlane_b32 s50, v3
    s_lshr_b32 s50, s50, 1
    s_nop 4
    v_cvt_pk_bf16_f32 v168, v160, v161
    ds_bpermute_b32 v172, v197, v168
    v_cvt_pk_bf16_f32 v169, v162, v163
    ds_bpermute_b32 v173, v197, v169
    v_cvt_pk_bf16_f32 v170, v164, v165
    ds_bpermute_b32 v174, v197, v170
    v_cvt_pk_bf16_f32 v171, v166, v167
    ds_bpermute_b32 v175, v197, v171
    s_mov_b64 exec, 15
    s_waitcnt lgkmcnt(0)
    buffer_store_dwordx4 v[172:175], v192, s[28:31], s5 offen sc1
    s_mov_b64 exec, -1
    s_waitcnt vmcnt(0)
    ds_add_u32 v1, v2 offset:4352
L_s3:
WF_30:
    ds_read_b32 v3, v1 offset:0
    s_waitcnt lgkmcnt(0)
    v_cmp_gt_u32 vcc, 178, v3
    s_cbranch_vccnz WF_30
    ds_read_b128 v[64:67], v188 offset:0
    ds_read_b128 v[68:71], v189 offset:0
    ds_read_b128 v[72:75], v190 offset:0
    ds_read_b128 v[76:79], v191 offset:0
    ds_read_b128 v[80:83], v188 offset:256
    ds_read_b128 v[84:87], v189 offset:256
    ds_read_b128 v[88:91], v190 offset:256
    ds_read_b128 v[92:95], v191 offset:256
    ds_read_b128 v[96:99], v188 offset:512
    ds_read_b128 v[100:103], v189 offset:512
    ds_read_b128 v[104:107], v190 offset:512
    ds_read_b128 v[108:111], v191 offset:512
WF_31:
    ds_read_b32 v3, v1 offset:4352
    s_waitcnt lgkmcnt(0)
    v_cmp_gt_u32 vcc, 3, v3
    s_cbranch_vccnz WF_31
WF_32:
    ds_read_b32 v3, v1 offset:0
    s_waitcnt lgkmcnt(0)
    v_cmp_gt_u32 vcc, 208, v3
    s_cbranch_vccnz WF_32
    buffer_load_dwordx4 v[16:19], v208, s[28:31], s6 offen offset:0 sc1
    buffer_load_dwordx4 v[20:23], v208, s[28:31], s6 offen offset:512 sc1
    buffer_load_dwordx4 v[24:27], v208, s[28:31], s7 offen offset:0 sc1
    buffer_load_dwordx4 v[28:31], v208, s[28:31], s7 offen offset:512 sc1
    buffer_load_dwordx4 v[32:35], v208, s[28:31], s8 offen offset:0 sc1
    buffer_load_dwordx4 v[36:39], v208, s[28:31], s8 offen offset:512 sc1
    buffer_load_dwordx4 v[40:43], v208, s[28:31], s24 offen offset:0 sc1
    buffer_load_dwordx4 v[44:47], v208, s[28:31], s24 offen offset:512 sc1
    buffer_load_dwordx4 v[48:51], v208, s[28:31], s25 offen offset:0 sc1
    buffer_load_dwordx4 v[52:55], v208, s[28:31], s25 offen offset:512 sc1
    buffer_load_dwordx4 v[56:59], v208, s[28:31], s26 offen offset:0 sc1
    buffer_load_dwordx4 v[60:63], v208, s[28:31], s26 offen offset:512 sc1
    ds_add_u32 v1, v2 offset:4608
WF_33:
    ds_read_b32 v3, v1 offset:0
    s_waitcnt lgkmcnt(0)
    v_cmp_gt_u32 vcc, 226, v3
    s_cbranch_vccnz WF_33
    ds_read_b128 v[112:115], v188 offset:24576
    ds_read_b128 v[116:119], v189 offset:24576
    ds_read_b128 v[120:123], v190 offset:24576
    ds_read_b128 v[124:127], v191 offset:24576
    ds_read_b128 v[128:131], v188 offset:24832
    ds_read_b128 v[132:135], v189 offset:24832
    ds_read_b128 v[136:139], v190 offset:24832
    ds_read_b128 v[140:143], v191 offset:24832
    ds_read_b128 v[144:147], v188 offset:25088
    ds_read_b128 v[148:151], v189 offset:25088
    ds_read_b128 v[152:155], v190 offset:25088
    ds_read_b128 v[156:159], v191 offset:25088
    ds_add_u32 v1, v2 offset:2816
    s_waitcnt lgkmcnt(0)
    s_branch L_s3m
S3_34:
    s_sub_u32 s42, s42, 1
    s_cbranch_scc1 GU_35
    buffer_load_dwordx4 v[16:19], v208, s[28:31], s6 offen offset:0 sc1
    buffer_load_dwordx4 v[20:23], v208, s[28:31], s6 offen offset:512 sc1
    buffer_load_dwordx4 v[24:27], v208, s[28:31], s7 offen offset:0 sc1
    buffer_load_dwordx4 v[28:31], v208, s[28:31], s7 offen offset:512 sc1
    buffer_load_dwordx4 v[32:35], v208, s[28:31], s8 offen offset:0 sc1
    buffer_load_dwordx4 v[36:39], v208, s[28:31], s8 offen offset:512 sc1
    buffer_load_dwordx4 v[40:43], v208, s[28:31], s24 offen offset:0 sc1
    buffer_load_dwordx4 v[44:47], v208, s[28:31], s24 offen offset:512 sc1
    buffer_load_dwordx4 v[48:51], v208, s[28:31], s25 offen offset:0 sc1
    buffer_load_dwordx4 v[52:55], v208, s[28:31], s25 offen offset:512 sc1
    buffer_load_dwordx4 v[56:59], v208, s[28:31], s26 offen offset:0 sc1
    buffer_load_dwordx4 v[60:63], v208, s[28:31], s26 offen offset:512 sc1
L_s3m:
    s_mov_b32 vcc_lo, 0x55555555
    s_mov_b32 vcc_hi, 0x55555555
    s_waitcnt vmcnt(10)
    v_cndmask_b32_dpp v8, v20, v16, vcc quad_perm:[0,0,2,2] row_mask:0xf bank_mask:0xf
    v_cndmask_b32_dpp v9, v21, v17, vcc quad_perm:[0,0,2,2] row_mask:0xf bank_mask:0xf
    v_cndmask_b32_dpp v10, v22, v18, vcc quad_perm:[0,0,2,2] row_mask:0xf bank_mask:0xf
    v_cndmask_b32_dpp v11, v23, v19, vcc quad_perm:[0,0,2,2] row_mask:0xf bank_mask:0xf
    s_not_b64 vcc, vcc
    v_cndmask_b32_dpp v20, v16, v20, vcc quad_perm:[1,1,3,3] row_mask:0xf bank_mask:0xf
    v_cndmask_b32_dpp v21, v17, v21, vcc quad_perm:[1,1,3,3] row_mask:0xf bank_mask:0xf
    v_cndmask_b32_dpp v22, v18, v22, vcc quad_perm:[1,1,3,3] row_mask:0xf bank_mask:0xf
    v_cndmask_b32_dpp v23, v19, v23, vcc quad_perm:[1,1,3,3] row_mask:0xf bank_mask:0xf
    s_not_b64 vcc, vcc
    v_mfma_f32_16x16x32_bf16 v[160:163], v[64:67], v[8:11], 0
    s_waitcnt vmcnt(8)
    v_cndmask_b32_dpp v12, v28, v24, vcc quad_perm:[0,0,2,2] row_mask:0xf bank_mask:0xf
    v_cndmask_b32_dpp v13, v29, v25, vcc quad_perm:[0,0,2,2] row_mask:0xf bank_mask:0xf
    v_mfma_f32_16x16x32_bf16 v[164:167], v[112:115], v[8:11], 0
    v_cndmask_b32_dpp v14, v30, v26, vcc quad_perm:[0,0,2,2] row_mask:0xf bank_mask:0xf
    v_cndmask_b32_dpp v15, v31, v27, vcc quad_perm:[0,0,2,2] row_mask:0xf bank_mask:0xf
    s_not_b64 vcc, vcc
    v_mfma_f32_16x16x32_bf16 v[160:163], v[68:71], v[20:23], v[160:163]
    v_cndmask_b32_dpp v28, v24, v28, vcc quad_perm:[1,1,3,3] row_mask:0xf bank_mask:0xf
    v_cndmask_b32_dpp v29, v25, v29, vcc quad_perm:[1,1,3,3] row_mask:0xf bank_mask:0xf
    v_mfma_f32_16x16x32_bf16 v[164:167], v[116:119], v[20:23], v[164:167]
    v_cndmask_b32_dpp v30, v26, v30, vcc quad_perm:[1,1,3,3] row_mask:0xf bank_mask:0xf
    v_cndmask_b32_dpp v31, v27, v31, vcc quad_perm:[1,1,3,3] row_mask:0xf bank_mask:0xf
    s_not_b64 vcc, vcc
    v_mfma_f32_16x16x32_bf16 v[160:163], v[72:75], v[12:15], v[160:163]
    s_waitcnt vmcnt(6)
    v_cndmask_b32_dpp v8, v36, v32, vcc quad_perm:[0,0,2,2] row_mask:0xf bank_mask:0xf
    v_cndmask_b32_dpp v9, v37, v33, vcc quad_perm:[0,0,2,2] row_mask:0xf bank_mask:0xf
    v_mfma_f32_16x16x32_bf16 v[164:167], v[120:123], v[12:15], v[164:167]
    v_cndmask_b32_dpp v10, v38, v34, vcc quad_perm:[0,0,2,2] row_mask:0xf bank_mask:0xf
    v_cndmask_b32_dpp v11, v39, v35, vcc quad_perm:[0,0,2,2] row_mask:0xf bank_mask:0xf
    s_not_b64 vcc, vcc
    v_mfma_f32_16x16x32_bf16 v[160:163], v[76:79], v[28:31], v[160:163]
    v_cndmask_b32_dpp v36, v32, v36, vcc quad_perm:[1,1,3,3] row_mask:0xf bank_mask:0xf
    v_cndmask_b32_dpp v37, v33, v37, vcc quad_perm:[1,1,3,3] row_mask:0xf bank_mask:0xf
    v_mfma_f32_16x16x32_bf16 v[164:167], v[124:127], v[28:31], v[164:167]
    v_cndmask_b32_dpp v38, v34, v38, vcc quad_perm:[1,1,3,3] row_mask:0xf bank_mask:0xf
    v_cndmask_b32_dpp v39, v35, v39, vcc quad_perm:[1,1,3,3] row_mask:0xf bank_mask:0xf
    s_not_b64 vcc, vcc
    v_mfma_f32_16x16x32_bf16 v[160:163], v[80:83], v[8:11], v[160:163]
    s_waitcnt vmcnt(4)
    v_cndmask_b32_dpp v12, v44, v40, vcc quad_perm:[0,0,2,2] row_mask:0xf bank_mask:0xf
    v_cndmask_b32_dpp v13, v45, v41, vcc quad_perm:[0,0,2,2] row_mask:0xf bank_mask:0xf
    v_mfma_f32_16x16x32_bf16 v[164:167], v[128:131], v[8:11], v[164:167]
    v_cndmask_b32_dpp v14, v46, v42, vcc quad_perm:[0,0,2,2] row_mask:0xf bank_mask:0xf
    v_cndmask_b32_dpp v15, v47, v43, vcc quad_perm:[0,0,2,2] row_mask:0xf bank_mask:0xf
    s_not_b64 vcc, vcc
    v_mfma_f32_16x16x32_bf16 v[160:163], v[84:87], v[36:39], v[160:163]
    v_cndmask_b32_dpp v44, v40, v44, vcc quad_perm:[1,1,3,3] row_mask:0xf bank_mask:0xf
    v_cndmask_b32_dpp v45, v41, v45, vcc quad_perm:[1,1,3,3] row_mask:0xf bank_mask:0xf
    v_mfma_f32_16x16x32_bf16 v[164:167], v[132:135], v[36:39], v[164:167]
    v_cndmask_b32_dpp v46, v42, v46, vcc quad_perm:[1,1,3,3] row_mask:0xf bank_mask:0xf
    v_cndmask_b32_dpp v47, v43, v47, vcc quad_perm:[1,1,3,3] row_mask:0xf bank_mask:0xf
    s_not_b64 vcc, vcc
    v_mfma_f32_16x16x32_bf16 v[160:163], v[88:91], v[12:15], v[160:163]
    s_waitcnt vmcnt(2)
    v_cndmask_b32_dpp v8, v52, v48, vcc quad_perm:[0,0,2,2] row_mask:0xf bank_mask:0xf
    v_cndmask_b32_dpp v9, v53, v49, vcc quad_perm:[0,0,2,2] row_mask:0xf bank_mask:0xf
    v_mfma_f32_16x16x32_bf16 v[164:167], v[136:139], v[12:15], v[164:167]
    v_cndmask_b32_dpp v10, v54, v50, vcc quad_perm:[0,0,2,2] row_mask:0xf bank_mask:0xf
    v_cndmask_b32_dpp v11, v55, v51, vcc quad_perm:[0,0,2,2] row_mask:0xf bank_mask:0xf
    s_not_b64 vcc, vcc
    v_mfma_f32_16x16x32_bf16 v[160:163], v[92:95], v[44:47], v[160:163]
    v_cndmask_b32_dpp v52, v48, v52, vcc quad_perm:[1,1,3,3] row_mask:0xf bank_mask:0xf
    v_cndmask_b32_dpp v53, v49, v53, vcc quad_perm:[1,1,3,3] row_mask:0xf bank_mask:0xf
    v_mfma_f32_16x16x32_bf16 v[164:167], v[140:143], v[44:47], v[164:167]
    v_cndmask_b32_dpp v54, v50, v54, vcc quad_perm:[1,1,3,3] row_mask:0xf bank_mask:0xf
    v_cndmask_b32_dpp v55, v51, v55, vcc quad_perm:[1,1,3,3] row_mask:0xf bank_mask:0xf
    s_not_b64 vcc, vcc
    v_mfma_f32_16x16x32_bf16 v[160:163], v[96:99], v[8:11], v[160:163]
    s_waitcnt vmcnt(0)
    v_cndmask_b32_dpp v12, v60, v56, vcc quad_perm:[0,0,2,2] row_mask:0xf bank_mask:0xf
    v_cndmask_b32_dpp v13, v61, v57, vcc quad_perm:[0,0,2,2] row_mask:0xf bank_mask:0xf
    v_mfma_f32_16x16x32_bf16 v[164:167], v[144:147], v[8:11], v[164:167]
    v_cndmask_b32_dpp v14, v62, v58, vcc quad_perm:[0,0,2,2] row_mask:0xf bank_mask:0xf
    v_cndmask_b32_dpp v15, v63, v59, vcc quad_perm:[0,0,2,2] row_mask:0xf bank_mask:0xf
    s_not_b64 vcc, vcc
    v_mfma_f32_16x16x32_bf16 v[160:163], v[100:103], v[52:55], v[160:163]
    v_cndmask_b32_dpp v60, v56, v60, vcc quad_perm:[1,1,3,3] row_mask:0xf bank_mask:0xf
    v_cndmask_b32_dpp v61, v57, v61, vcc quad_perm:[1,1,3,3] row_mask:0xf bank_mask:0xf
    v_mfma_f32_16x16x32_bf16 v[164:167], v[148:151], v[52:55], v[164:167]
    v_cndmask_b32_dpp v62, v58, v62, vcc quad_perm:[1,1,3,3] row_mask:0xf bank_mask:0xf
    v_cndmask_b32_dpp v63, v59, v63, vcc quad_perm:[1,1,3,3] row_mask:0xf bank_mask:0xf
    s_not_b64 vcc, vcc
    v_mfma_f32_16x16x32_bf16 v[160:163], v[104:107], v[12:15], v[160:163]
    v_mfma_f32_16x16x32_bf16 v[164:167], v[152:155], v[12:15], v[164:167]
    v_mfma_f32_16x16x32_bf16 v[160:163], v[108:111], v[60:63], v[160:163]
    v_mfma_f32_16x16x32_bf16 v[164:167], v[156:159], v[60:63], v[164:167]
    s_cmp_eq_u32 s53, 0
    s_nop 6
    v_cmp_u_f32 vcc, v160, v164
    s_cbranch_vccnz S3_34
OK_36:
    s_cbranch_scc1 L_soft
    ds_write_b128 v204, v[160:163]
    ds_write_b128 v204, v[164:167] offset:1024
    ds_add_u32 v6, v2 offset:1280
    s_branch L_s4
L_soft:
XW_37:
    ds_read_b32 v3, v6 offset:1280
    ds_read_b128 v[168:171], v204
    ds_read_b128 v[172:175], v204 offset:1024
    s_waitcnt lgkmcnt(0)
    v_cmp_gt_u32 vcc, 1, v3
    s_cbranch_vccnz XW_37
    v_pk_add_f32 v[160:161], v[160:161], v[168:169]
    v_pk_add_f32 v[162:163], v[162:163], v[170:171]
    v_pk_add_f32 v[164:165], v[164:165], v[172:173]
    v_pk_add_f32 v[166:167], v[166:167], v[174:175]
    v_max3_f32 v8, v160, v161, v162
    v_max3_f32 v9, v163, v164, v165
    v_max3_f32 v8, v8, v166, v167
    v_max_f32 v8, v8, v9
    v_mov_b32 v9, v8
    s_nop 1
    v_permlane16_swap_b32 v8, v9
    v_max_f32 v8, v8, v9
    v_mov_b32 v9, v8
    s_nop 1
    v_permlane32_swap_b32 v8, v9
    v_max_f32 v8, v8, v9
    v_ceil_f32 v8, v8
    s_cmp_eq_u32 s50, 0
    v_pk_add_f32 v[160:161], v[160:161], v[8:9] op_sel_hi:[1,0] neg_lo:[0,1] neg_hi:[0,1]
    v_pk_add_f32 v[162:163], v[162:163], v[8:9] op_sel_hi:[1,0] neg_lo:[0,1] neg_hi:[0,1]
    v_pk_add_f32 v[164:165], v[164:165], v[8:9] op_sel_hi:[1,0] neg_lo:[0,1] neg_hi:[0,1]
    v_pk_add_f32 v[166:167], v[166:167], v[8:9] op_sel_hi:[1,0] neg_lo:[0,1] neg_hi:[0,1]
    v_exp_f32 v160, v160
    v_exp_f32 v161, v161
    v_exp_f32 v162, v162
    v_exp_f32 v163, v163
    v_exp_f32 v164, v164
    v_exp_f32 v165, v165
    v_exp_f32 v166, v166
    v_exp_f32 v167, v167
    v_cvt_pk_bf16_f32 v168, v160, v161
    v_cvt_pk_bf16_f32 v169, v162, v163
    v_cvt_pk_bf16_f32 v170, v164, v165
    v_cvt_pk_bf16_f32 v171, v166, v167
    s_cbranch_scc0 RM_38
    buffer_store_dwordx4 v[168:171], v192, s[28:31], s9 offen
    s_mov_b64 exec, 0xffff
    buffer_store_dword v8, v205, s[28:31], s10 offen
BK_39:
    s_mov_b64 exec, -1
    v_pk_add_f32 v[160:161], v[160:161], v[162:163]
    v_pk_add_f32 v[164:165], v[164:165], v[166:167]
    v_pk_add_f32 v[160:161], v[160:161], v[164:165]
    v_add_f32 v9, v160, v161
    ds_write_b64 v203, v[8:9]
    ds_add_u32 v1, v2 offset:3328
L_s4:
    ds_read_b64_tr_b16 v[64:65], v193 offset:0
    ds_read_b64_tr_b16 v[66:67], v193 offset:25600
    ds_read_b64_tr_b16 v[68:69], v194 offset:0
    ds_read_b64_tr_b16 v[70:71], v194 offset:25600
    ds_read_b64_tr_b16 v[72:73], v199 offset:0
    ds_read_b64_tr_b16 v[74:75], v199 offset:25600
    ds_read_b64_tr_b16 v[76:77], v193 offset:6400
    ds_read_b64_tr_b16 v[78:79], v193 offset:32000
    ds_read_b64_tr_b16 v[80:81], v194 offset:6400
    ds_read_b64_tr_b16 v[82:83], v194 offset:32000
    ds_read_b64_tr_b16 v[84:85], v199 offset:6400
    ds_read_b64_tr_b16 v[86:87], v199 offset:32000
    ds_read_b64_tr_b16 v[88:89], v193 offset:12800
    ds_read_b64_tr_b16 v[90:91], v193 offset:38400
    ds_read_b64_tr_b16 v[92:93], v194 offset:12800
    ds_read_b64_tr_b16 v[94:95], v194 offset:38400
    ds_read_b64_tr_b16 v[96:97], v199 offset:12800
    ds_read_b64_tr_b16 v[98:99], v199 offset:38400
    ds_read_b64_tr_b16 v[100:101], v193 offset:19200
    ds_read_b64_tr_b16 v[102:103], v193 offset:44800
    ds_read_b64_tr_b16 v[104:105], v194 offset:19200
    ds_read_b64_tr_b16 v[106:107], v194 offset:44800
    ds_read_b64_tr_b16 v[108:109], v199 offset:19200
    ds_read_b64_tr_b16 v[110:111], v199 offset:44800
    ds_read_b64_tr_b16 v[112:113], v193 offset:384
    ds_read_b64_tr_b16 v[114:115], v193 offset:25984
    ds_read_b64_tr_b16 v[116:117], v194 offset:384
    ds_read_b64_tr_b16 v[118:119], v194 offset:25984
    ds_read_b64_tr_b16 v[120:121], v199 offset:384
    ds_read_b64_tr_b16 v[122:123], v199 offset:25984
    ds_read_b64_tr_b16 v[124:125], v193 offset:6784
    ds_read_b64_tr_b16 v[126:127], v193 offset:32384
    ds_read_b64_tr_b16 v[128:129], v194 offset:6784
    ds_read_b64_tr_b16 v[130:131], v194 offset:32384
    ds_read_b64_tr_b16 v[132:133], v199 offset:6784
    ds_read_b64_tr_b16 v[134:135], v199 offset:32384
    ds_read_b64_tr_b16 v[136:137], v193 offset:13184
    ds_read_b64_tr_b16 v[138:139], v193 offset:38784
    ds_read_b64_tr_b16 v[140:141], v194 offset:13184
    ds_read_b64_tr_b16 v[142:143], v194 offset:38784
    ds_read_b64_tr_b16 v[144:145], v199 offset:13184
    ds_read_b64_tr_b16 v[146:147], v199 offset:38784
    ds_read_b64_tr_b16 v[148:149], v193 offset:19584
    ds_read_b64_tr_b16 v[150:151], v193 offset:45184
    ds_read_b64_tr_b16 v[152:153], v194 offset:19584
    ds_read_b64_tr_b16 v[154:155], v194 offset:45184
    ds_read_b64_tr_b16 v[156:157], v199 offset:19584
    ds_read_b64_tr_b16 v[158:159], v199 offset:45184
WF_40:
    ds_read_b32 v3, v1 offset:3328
    s_waitcnt lgkmcnt(0)
    v_cmp_gt_u32 vcc, 2, v3
    s_cbranch_vccnz WF_40
    v_mov_b32 v13, 1
S4_41:
    s_sub_u32 s42, s42, 1
    s_cbranch_scc1 GU_42
    buffer_load_dword v8, v196, s[28:31], s13 offen sc1
    buffer_load_dword v9, v196, s[28:31], s14 offen sc1
L_s4w:
    s_waitcnt vmcnt(0)
    v_cmp_u_f32 vcc, v8, v9
    v_max_f32 v10, v8, v9
    s_cbranch_vccnz S4_41
L_s4p:
    buffer_load_dwordx4 v[16:19], v195, s[28:31], s11 offen offset:0 sc1
    buffer_load_dwordx4 v[20:23], v195, s[28:31], s11 offen offset:256 sc1
    buffer_load_dwordx4 v[24:27], v195, s[28:31], s11 offen offset:512 sc1
    buffer_load_dwordx4 v[28:31], v195, s[28:31], s11 offen offset:768 sc1
    buffer_load_dwordx4 v[32:35], v195, s[28:31], s12 offen offset:0 sc1
    buffer_load_dwordx4 v[36:39], v195, s[28:31], s12 offen offset:256 sc1
    buffer_load_dwordx4 v[40:43], v195, s[28:31], s12 offen offset:512 sc1
    buffer_load_dwordx4 v[44:47], v195, s[28:31], s12 offen offset:768 sc1
    ds_add_u32 v1, v13 offset:2304
    v_mov_b32 v13, 0
    ds_read_b32 v14, v1 offset:6912
    v_mov_b32 v11, v10
    s_nop 1
    v_permlane16_swap_b32 v10, v11
    v_max_f32 v10, v10, v11
    v_mov_b32 v11, v10
    s_nop 1
    v_permlane32_swap_b32 v10, v11
    v_max_f32 v10, v10, v11
    v_sub_f32 v8, v10, v8
    v_sub_f32 v9, v10, v9
    v_min_f32 v8, s49, v8
    v_min_f32 v9, s49, v9
    v_cvt_u32_f32 v8, v8
    v_cvt_u32_f32 v9, v9
    v_mul_u32_u24 v8, s48, v8
    v_mul_u32_u24 v9, s48, v9
    s_waitcnt vmcnt(7)
    v_pk_sub_u16 v16, v16, v8 clamp
    v_pk_sub_u16 v17, v17, v8 clamp
    v_pk_sub_u16 v18, v18, v8 clamp
    v_pk_sub_u16 v19, v19, v8 clamp
    v_or3_b32 v12, v16, v17, v18
    v_or_b32 v12, v12, v19
    v_mfma_f32_16x16x32_bf16 v[160:163], v[64:67], v[16:19], 0
    s_waitcnt vmcnt(6)
    v_pk_sub_u16 v20, v20, v8 clamp
    v_pk_sub_u16 v21, v21, v8 clamp
    v_mfma_f32_16x16x32_bf16 v[164:167], v[68:71], v[16:19], 0
    v_pk_sub_u16 v22, v22, v8 clamp
    v_pk_sub_u16 v23, v23, v8 clamp
    v_mfma_f32_16x16x32_bf16 v[168:171], v[72:75], v[16:19], 0
    v_or3_b32 v12, v12, v20, v21
    v_or3_b32 v12, v12, v22, v23
    v_mfma_f32_16x16x32_bf16 v[160:163], v[76:79], v[20:23], v[160:163]
    s_waitcnt vmcnt(5)
    v_pk_sub_u16 v24, v24, v8 clamp
    v_pk_sub_u16 v25, v25, v8 clamp
    v_mfma_f32_16x16x32_bf16 v[164:167], v[80:83], v[20:23], v[164:167]
    v_pk_sub_u16 v26, v26, v8 clamp
    v_pk_sub_u16 v27, v27, v8 clamp
    v_mfma_f32_16x16x32_bf16 v[168:171], v[84:87], v[20:23], v[168:171]
    v_or3_b32 v12, v12, v24, v25
    v_or3_b32 v12, v12, v26, v27
    v_mfma_f32_16x16x32_bf16 v[160:163], v[88:91], v[24:27], v[160:163]
    s_waitcnt vmcnt(4)
    v_pk_sub_u16 v28, v28, v8 clamp
    v_pk_sub_u16 v29, v29, v8 clamp
    v_mfma_f32_16x16x32_bf16 v[164:167], v[92:95], v[24:27], v[164:167]
    v_pk_sub_u16 v30, v30, v8 clamp
    v_pk_sub_u16 v31, v31, v8 clamp
    v_mfma_f32_16x16x32_bf16 v[168:171], v[96:99], v[24:27], v[168:171]
    v_or3_b32 v12, v12, v28, v29
    v_or3_b32 v12, v12, v30, v31
    v_mfma_f32_16x16x32_bf16 v[160:163], v[100:103], v[28:31], v[160:163]
    s_waitcnt vmcnt(3)
    v_pk_sub_u16 v32, v32, v9 clamp
    v_pk_sub_u16 v33, v33, v9 clamp
    v_mfma_f32_16x16x32_bf16 v[164:167], v[104:107], v[28:31], v[164:167]
    v_pk_sub_u16 v34, v34, v9 clamp
    v_pk_sub_u16 v35, v35, v9 clamp
    v_mfma_f32_16x16x32_bf16 v[168:171], v[108:111], v[28:31], v[168:171]
    v_or3_b32 v12, v12, v32, v33
    v_or3_b32 v12, v12, v34, v35
    v_mfma_f32_16x16x32_bf16 v[160:163], v[112:115], v[32:35], v[160:163]
    s_waitcnt vmcnt(2)
    v_pk_sub_u16 v36, v36, v9 clamp
    v_pk_sub_u16 v37, v37, v9 clamp
    v_mfma_f32_16x16x32_bf16 v[164:167], v[116:119], v[32:35], v[164:167]
    v_pk_sub_u16 v38, v38, v9 clamp
    v_pk_sub_u16 v39, v39, v9 clamp
    v_mfma_f32_16x16x32_bf16 v[168:171], v[120:123], v[32:35], v[168:171]
    v_or3_b32 v12, v12, v36, v37
    v_or3_b32 v12, v12, v38, v39
    v_mfma_f32_16x16x32_bf16 v[160:163], v[124:127], v[36:39], v[160:163]
    s_waitcnt vmcnt(1)
    v_pk_sub_u16 v40, v40, v9 clamp
    v_pk_sub_u16 v41, v41, v9 clamp
    v_mfma_f32_16x16x32_bf16 v[164:167], v[128:131], v[36:39], v[164:167]
    v_pk_sub_u16 v42, v42, v9 clamp
    v_pk_sub_u16 v43, v43, v9 clamp
    v_mfma_f32_16x16x32_bf16 v[168:171], v[132:135], v[36:39], v[168:171]
    v_or3_b32 v12, v12, v40, v41
    v_or3_b32 v12, v12, v42, v43
    v_mfma_f32_16x16x32_bf16 v[160:163], v[136:139], v[40:43], v[160:163]
    s_waitcnt vmcnt(0)
    v_pk_sub_u16 v44, v44, v9 clamp
    v_pk_sub_u16 v45, v45, v9 clamp
    v_mfma_f32_16x16x32_bf16 v[164:167], v[140:143], v[40:43], v[164:167]
    v_pk_sub_u16 v46, v46, v9 clamp
    v_pk_sub_u16 v47, v47, v9 clamp
    v_mfma_f32_16x16x32_bf16 v[168:171], v[144:147], v[40:43], v[168:171]
    v_or3_b32 v12, v12, v44, v45
    v_or3_b32 v12, v12, v46, v47
    v_mfma_f32_16x16x32_bf16 v[160:163], v[148:151], v[44:47], v[160:163]
    v_mfma_f32_16x16x32_bf16 v[164:167], v[152:155], v[44:47], v[164:167]
    v_mfma_f32_16x16x32_bf16 v[168:171], v[156:159], v[44:47], v[168:171]
    v_and_b32 v12, 0x80008000, v12
    v_cmp_ne_u32 vcc, 0, v12
    s_cbranch_vccnz S4_41
OK_43:
    s_waitcnt lgkmcnt(0)
    v_cmp_ne_u32 vcc, 1, v14
    s_cbranch_vccnz GW_44
GB_45:
    ds_add_u32 v1, v2 offset:5888
    v_cvt_pk_bf16_f32 v16, v160, v161
    ds_bpermute_b32 v212, v197, v16
    v_cvt_pk_bf16_f32 v17, v162, v163
    ds_bpermute_b32 v213, v197, v17
    v_cvt_pk_bf16_f32 v18, v164, v165
    ds_bpermute_b32 v214, v197, v18
    v_cvt_pk_bf16_f32 v19, v166, v167
    ds_bpermute_b32 v216, v197, v19
    v_cvt_pk_bf16_f32 v20, v168, v169
    ds_bpermute_b32 v217, v197, v20
    v_cvt_pk_bf16_f32 v21, v170, v171
    ds_bpermute_b32 v218, v197, v21
    s_waitcnt lgkmcnt(3)
    buffer_store_dwordx4 v[212:215], v198, s[28:31], s15 offen sc1
    s_waitcnt lgkmcnt(0)
    buffer_store_dwordx4 v[216:219], v198, s[28:31], s15 offen offset:64 sc1
    ds_add_u32 v1, v2 offset:4864
    s_waitcnt vmcnt(0)
    ds_add_u32 v1, v2 offset:3584
    s_cmp_eq_u32 s34, 3
    s_cbranch_scc1 L_s6
WF_46:
    ds_read_b32 v3, v1 offset:0
    s_waitcnt lgkmcnt(0)
    v_cmp_gt_u32 vcc, s47, v3
    s_cbranch_vccnz WF_46
    ds_read_b64_tr_b16 v[64:65], v180 offset:0
    ds_read_b64_tr_b16 v[66:67], v180 offset:6144
    ds_read_b64_tr_b16 v[68:69], v180 offset:12288
    ds_read_b64_tr_b16 v[70:71], v180 offset:18432
    ds_read_b64_tr_b16 v[72:73], v180 offset:24576
    ds_read_b64_tr_b16 v[74:75], v180 offset:30720
    ds_read_b64_tr_b16 v[76:77], v181 offset:0
    ds_read_b64_tr_b16 v[78:79], v181 offset:6144
    ds_read_b64_tr_b16 v[80:81], v181 offset:12288
    ds_read_b64_tr_b16 v[82:83], v181 offset:18432
    ds_read_b64_tr_b16 v[84:85], v181 offset:24576
    ds_read_b64_tr_b16 v[86:87], v181 offset:30720
    ds_read_b64_tr_b16 v[88:89], v182 offset:0
    ds_read_b64_tr_b16 v[90:91], v182 offset:6144
    ds_read_b64_tr_b16 v[92:93], v182 offset:12288
    ds_read_b64_tr_b16 v[94:95], v182 offset:18432
    ds_read_b64_tr_b16 v[96:97], v182 offset:24576
    ds_read_b64_tr_b16 v[98:99], v182 offset:30720
    ds_read_b64_tr_b16 v[100:101], v183 offset:0
    ds_read_b64_tr_b16 v[102:103], v183 offset:6144
    ds_read_b64_tr_b16 v[104:105], v183 offset:12288
    ds_read_b64_tr_b16 v[106:107], v183 offset:18432
    ds_read_b64_tr_b16 v[108:109], v183 offset:24576
    ds_read_b64_tr_b16 v[110:111], v183 offset:30720
V1_47:
    ds_read_b32 v3, v1 offset:1792
    ds_read_b128 v[16:19], v184 offset:320
    ds_read_b128 v[20:23], v184 offset:384
    ds_read_b128 v[24:27], v184 offset:448
    s_waitcnt lgkmcnt(0)
    v_cmp_gt_u32 vcc, 1, v3
    s_cbranch_vccnz V1_47
    v_mfma_f32_16x16x32_bf16 v[160:163], v[64:67], v[16:19], 0
    v_mfma_f32_16x16x32_bf16 v[160:163], v[68:71], v[20:23], v[160:163]
    v_mfma_f32_16x16x32_bf16 v[160:163], v[72:75], v[24:27], v[160:163]
    v_mfma_f32_16x16x32_bf16 v[164:167], v[76:79], v[16:19], 0
    v_mfma_f32_16x16x32_bf16 v[164:167], v[80:83], v[20:23], v[164:167]
    v_mfma_f32_16x16x32_bf16 v[164:167], v[84:87], v[24:27], v[164:167]
    v_mfma_f32_16x16x32_bf16 v[168:171], v[88:91], v[16:19], 0
    v_mfma_f32_16x16x32_bf16 v[168:171], v[92:95], v[20:23], v[168:171]
    v_mfma_f32_16x16x32_bf16 v[168:171], v[96:99], v[24:27], v[168:171]
    v_mfma_f32_16x16x32_bf16 v[172:175], v[100:103], v[16:19], 0
    v_mfma_f32_16x16x32_bf16 v[172:175], v[104:107], v[20:23], v[172:175]
    v_mfma_f32_16x16x32_bf16 v[172:175], v[108:111], v[24:27], v[172:175]
    s_cmp_eq_u32 s50, 0
    s_mov_b64 exec, s[56:57]
    v_cvt_pk_bf16_f32 v176, v160, v161
    v_cvt_pk_bf16_f32 v177, v162, v163
    s_mov_b64 exec, s[58:59]
    v_cvt_pk_bf16_f32 v176, v164, v165
    v_cvt_pk_bf16_f32 v177, v166, v167
    s_mov_b64 exec, s[60:61]
    v_cvt_pk_bf16_f32 v176, v168, v169
    v_cvt_pk_bf16_f32 v177, v170, v171
    s_mov_b64 exec, s[62:63]
    v_cvt_pk_bf16_f32 v176, v172, v173
    v_cvt_pk_bf16_f32 v177, v174, v175
    s_mov_b32 exec_lo, 0x000f000f
    s_mov_b32 exec_hi, 0x000f000f
    s_cbranch_scc0 RM_48
    buffer_store_dwordx4 v[176:179], v185, s[28:31], s16 offen offset:0
BK_49:
    s_mov_b64 exec, -1
    ds_add_u32 v1, v2 offset:3840
L_s6:
    s_cmp_lt_u32 s38, 5
    s_cbranch_scc0 L_fin
L_s6go:
    v_lshlrev_b32 v6, 2, v0
    s_mov_b32 s56, 0xffff0000
    s_mov_b32 s57, 0
WF_50:
    ds_read_b32 v3, v1 offset:0
    s_waitcnt lgkmcnt(0)
    v_cmp_gt_u32 vcc, s19, v3
    s_cbranch_vccnz WF_50
    ds_read_b64_tr_b16 v[112:113], v200 offset:0
    ds_read_b64_tr_b16 v[114:115], v200 offset:4096
    ds_read_b64_tr_b16 v[116:117], v201 offset:0
    ds_read_b64_tr_b16 v[118:119], v201 offset:4096
    ds_read_b64_tr_b16 v[120:121], v200 offset:8192
    ds_read_b64_tr_b16 v[122:123], v200 offset:12288
    ds_read_b64_tr_b16 v[124:125], v201 offset:8192
    ds_read_b64_tr_b16 v[126:127], v201 offset:12288
    ds_read_b64_tr_b16 v[128:129], v200 offset:16384
    ds_read_b64_tr_b16 v[130:131], v200 offset:20480
    ds_read_b64_tr_b16 v[132:133], v201 offset:16384
    ds_read_b64_tr_b16 v[134:135], v201 offset:20480
WF_51:
    ds_read_b32 v3, v1 offset:0
    s_waitcnt lgkmcnt(0)
    v_cmp_gt_u32 vcc, 310, v3
    s_cbranch_vccnz WF_51
    ds_read_b64_tr_b16 v[136:137], v200 offset:24576
    ds_read_b64_tr_b16 v[138:139], v200 offset:28672
    ds_read_b64_tr_b16 v[140:141], v201 offset:24576
    ds_read_b64_tr_b16 v[142:143], v201 offset:28672
    ds_read_b64_tr_b16 v[144:145], v200 offset:32768
    ds_read_b64_tr_b16 v[146:147], v200 offset:36864
    ds_read_b64_tr_b16 v[148:149], v201 offset:32768
    ds_read_b64_tr_b16 v[150:151], v201 offset:36864
    ds_read_b64_tr_b16 v[152:153], v200 offset:40960
    ds_read_b64_tr_b16 v[154:155], v200 offset:45056
    ds_read_b64_tr_b16 v[156:157], v201 offset:40960
    ds_read_b64_tr_b16 v[158:159], v201 offset:45056
V2_52:
    ds_read_b32 v3, v1 offset:2048
    ds_read_b128 v[16:19], v184 offset:896
    ds_read_b128 v[20:23], v184 offset:960
    ds_read_b128 v[24:27], v184 offset:1024
    ds_read_b128 v[28:31], v184 offset:1088
    ds_read_b128 v[32:35], v184 offset:1152
    ds_read_b128 v[36:39], v184 offset:1216
    s_waitcnt lgkmcnt(6)
    v_cmp_gt_u32 vcc, 1, v3
    s_cbranch_vccnz V2_52
    s_waitcnt lgkmcnt(5)
    v_mfma_f32_16x16x32_bf16 v[160:163], v[16:19], v[112:115], 0
    v_mfma_f32_16x16x32_bf16 v[164:167], v[16:19], v[116:119], 0
    s_waitcnt lgkmcnt(4)
    v_mfma_f32_16x16x32_bf16 v[160:163], v[20:23], v[120:123], v[160:163]
    v_mfma_f32_16x16x32_bf16 v[164:167], v[20:23], v[124:127], v[164:167]
    s_waitcnt lgkmcnt(3)
    v_mfma_f32_16x16x32_bf16 v[160:163], v[24:27], v[128:131], v[160:163]
    v_mfma_f32_16x16x32_bf16 v[164:167], v[24:27], v[132:135], v[164:167]
    s_waitcnt lgkmcnt(2)
    v_mfma_f32_16x16x32_bf16 v[160:163], v[28:31], v[136:139], v[160:163]
    v_mfma_f32_16x16x32_bf16 v[164:167], v[28:31], v[140:143], v[164:167]
    s_waitcnt lgkmcnt(1)
    v_mfma_f32_16x16x32_bf16 v[160:163], v[32:35], v[144:147], v[160:163]
    v_mfma_f32_16x16x32_bf16 v[164:167], v[32:35], v[148:151], v[164:167]
    s_waitcnt lgkmcnt(0)
    v_mfma_f32_16x16x32_bf16 v[160:163], v[36:39], v[152:155], v[160:163]
    v_mfma_f32_16x16x32_bf16 v[164:167], v[36:39], v[156:159], v[164:167]
    s_mov_b32 exec_hi, 0
    s_nop 6
    v_cndmask_b32 v7, v160, v164, s[56:57]
    buffer_store_dword v7, v6, s[28:31], s54 offen sc1
    s_mov_b64 exec, -1
    s_waitcnt vmcnt(0)
    ds_add_u32 v1, v2 offset:4096
    s_branch L_fin
L_w7:
    s_movk_i32 s43, 118
    s_waitcnt lgkmcnt(0)
    s_add_u32 s32, s32, 0x7f4a7c10
    s_addc_u32 s33, s33, 0x9e3779b9
    s_or_b32 s32, s32, 15
L_ga:
    s_setprio 2
    v_mul_u32_u24 v24, 12032, v5
    v_lshl_add_u32 v24, v4, 4, v24
    v_and_b32 v6, 1, v4
    v_lshlrev_b32 v6, 4, v6
    v_mov_b32 v7, 0x3f80
    v_lshlrev_b32 v6, v6, v7
    v_lshrrev_b32 v7, 1, v4
    v_cmp_eq_u32 vcc, 0, v7
    s_nop 1
    v_cndmask_b32 v16, 0, v6, vcc
    v_cmp_eq_u32 vcc, 1, v7
    s_nop 1
    v_cndmask_b32 v17, 0, v6, vcc
    v_cmp_eq_u32 vcc, 2, v7
    s_nop 1
    v_cndmask_b32 v18, 0, v6, vcc
    v_cmp_eq_u32 vcc, 3, v7
    s_nop 1
    v_cndmask_b32 v19, 0, v6, vcc
    v_cmp_eq_u32 vcc, 4, v7
    s_nop 1
    v_cndmask_b32 v20, 0, v6, vcc
    v_cmp_eq_u32 vcc, 5, v7
    s_nop 1
    v_cndmask_b32 v21, 0, v6, vcc
    v_lshlrev_b32 v28, 4, v0
    s_mul_i32 s61, s39, 12032
    s_add_u32 s61, s61, 4202496
    v_lshlrev_b32 v25, 7, v5
    v_and_b32 v6, 3, v4
    v_lshl_add_u32 v25, v6, 5, v25
    v_lshrrev_b32 v6, 2, v4
    v_lshl_add_u32 v25, v6, 3, v25
    v_add_u32 v25, 141824, v25
    v_lshlrev_b32 v26, 7, v5
    v_bfe_u32 v6, v4, 1, 1
    v_lshl_add_u32 v26, v6, 6, v26
    v_lshrrev_b32 v6, 2, v4
    v_lshl_add_u32 v26, v6, 4, v26
    v_and_b32 v6, 1, v4
    v_lshl_add_u32 v26, v6, 3, v26
    v_add_u32 v26, 142208, v26
    s_mul_i32 s54, s37, 96256
    s_add_u32 s52, s54, 4205568
    s_add_u32 s53, s52, 48128
    s_mov_b32 s48, s32
    s_xor_b32 s49, s33, 1
    s_mov_b32 s56, 1037384597
    s_mov_b32 s57, s56
    s_getreg_b32 s58, hwreg(HW_REG_XCC_ID, 0, 4)
    s_xor_b32 s58, s58, s32
    s_mov_b32 s59, s33
    v_mov_b32 v27, 1
WF_53:
    ds_read_b32 v3, v1 offset:3072
    s_waitcnt lgkmcnt(0)
    v_cmp_gt_u32 vcc, 3, v3
    s_cbranch_vccnz WF_53
WF_54:
    ds_read_b32 v3, v1 offset:0
    s_waitcnt lgkmcnt(0)
    v_cmp_gt_u32 vcc, s43, v3
    s_cbranch_vccnz WF_54
    s_andn2_b32 s42, s42, 15
GA_55:
    s_sub_u32 s42, s42, 1
    s_cbranch_scc1 GU_56
    buffer_load_dwordx4 v[32:35], v24, s[28:31], s52 offen offset:0 sc1
    buffer_load_dwordx4 v[36:39], v24, s[28:31], s52 offen offset:256 sc1
    buffer_load_dwordx4 v[40:43], v24, s[28:31], s52 offen offset:512 sc1
    buffer_load_dwordx4 v[44:47], v24, s[28:31], s53 offen offset:0 sc1
    buffer_load_dwordx4 v[48:51], v24, s[28:31], s53 offen offset:256 sc1
    buffer_load_dwordx4 v[52:55], v24, s[28:31], s53 offen offset:512 sc1
    s_waitcnt vmcnt(5)
    v_mfma_f32_16x16x16_bf16 v[72:75], v[16:17], v[32:33], 0
    s_waitcnt vmcnt(4)
    v_mfma_f32_16x16x16_bf16 v[72:75], v[18:19], v[36:37], v[72:75]
    s_waitcnt vmcnt(3)
    v_mfma_f32_16x16x16_bf16 v[72:75], v[20:21], v[40:41], v[72:75]
    s_waitcnt vmcnt(2)
    v_mfma_f32_16x16x16_bf16 v[72:75], v[16:17], v[44:45], v[72:75]
    s_waitcnt vmcnt(1)
    v_mfma_f32_16x16x16_bf16 v[72:75], v[18:19], v[48:49], v[72:75]
    s_waitcnt vmcnt(0)
    v_mfma_f32_16x16x16_bf16 v[72:75], v[20:21], v[52:53], v[72:75]
    v_cmpx_eq_u64 vcc, s[58:59], v[34:35]
    v_cmpx_eq_u64 vcc, s[58:59], v[38:39]
    v_cmpx_eq_u64 vcc, s[58:59], v[42:43]
    v_cmpx_eq_u64 vcc, s[58:59], v[46:47]
    v_cmpx_eq_u64 vcc, s[58:59], v[50:51]
    v_cmpx_eq_u64 vcc, s[58:59], v[54:55]
    s_cmp_eq_u64 exec, -1
    s_mov_b64 exec, -1
    s_cbranch_scc1 OK_57
    v_or_b32 v34, 15, v34
    v_cmpx_eq_u64 vcc, s[32:33], v[34:35]
    v_or_b32 v38, 15, v38
    v_cmpx_eq_u64 vcc, s[32:33], v[38:39]
    v_or_b32 v42, 15, v42
    v_cmpx_eq_u64 vcc, s[32:33], v[42:43]
    v_or_b32 v46, 15, v46
    v_cmpx_eq_u64 vcc, s[32:33], v[46:47]
    v_or_b32 v50, 15, v50
    v_cmpx_eq_u64 vcc, s[32:33], v[50:51]
    v_or_b32 v54, 15, v54
    v_cmpx_eq_u64 vcc, s[32:33], v[54:55]
    s_cmp_eq_u64 exec, -1
    s_mov_b64 exec, -1
    s_cselect_b32 s60, 0, s42
    s_cselect_b32 s63, 1, 0
    s_and_b32 s60, s60, 15
    s_cbranch_scc1 GA_55
    s_branch SL_58
OK_57:
    v_pk_mul_f32 v[72:73], v[72:73], s[56:57]
    v_pk_mul_f32 v[74:75], v[74:75], s[56:57]
    s_mov_b32 exec_hi, 0xffff
    v_cvt_pk_bf16_f32 v72, v72, v73
    v_cvt_pk_bf16_f32 v73, v74, v75
    ds_write_b64 v25, v[72:73]
    s_mov_b64 exec, -1
    ds_max_u32 v1, v27 offset:768
    s_mul_i32 s54, s35, 131072
    s_and_b32 s55, s37, 3
    s_lshl_b32 s55, s55, 4
    s_add_u32 s54, s54, s55
    s_add_u32 s44, s54, 1048576
    s_add_u32 s45, s44, 32768
    s_add_u32 s46, s44, 65536
    s_add_u32 s47, s44, 98304
    v_lshlrev_b32 v22, 6, v0
    v_add_u32 v23, 137216, v28
WF_59:
    ds_read_b32 v3, v1 offset:4864
    s_waitcnt lgkmcnt(0)
    v_cmp_gt_u32 vcc, 4, v3
    s_cbranch_vccnz WF_59
SS_60:
    s_sub_u32 s42, s42, 1
    s_cbranch_scc1 GU_61
    buffer_load_dwordx4 v[108:111], v22, s[28:31], s44 offen sc1
    buffer_load_dwordx4 v[112:115], v22, s[28:31], s45 offen sc1
    buffer_load_dwordx4 v[116:119], v22, s[28:31], s46 offen sc1
    buffer_load_dwordx4 v[120:123], v22, s[28:31], s47 offen sc1
    s_waitcnt vmcnt(0)
    v_cmpx_eq_u64 vcc, s[32:33], v[110:111]
    v_cmpx_eq_u64 vcc, s[32:33], v[114:115]
    v_cmpx_eq_u64 vcc, s[32:33], v[118:119]
    v_cmpx_eq_u64 vcc, s[32:33], v[122:123]
    s_cmp_eq_u64 exec, -1
    s_mov_b64 exec, -1
    s_cbranch_scc0 SS_60
OK_62:
    s_nop 1
    v_max_f32_dpp v32, v108, v108 quad_perm:[1,0,3,2] row_mask:0xf bank_mask:0xf
    v_max_f32_dpp v33, v112, v112 quad_perm:[1,0,3,2] row_mask:0xf bank_mask:0xf
    v_max_f32_dpp v34, v116, v116 quad_perm:[1,0,3,2] row_mask:0xf bank_mask:0xf
    v_max_f32_dpp v35, v120, v120 quad_perm:[1,0,3,2] row_mask:0xf bank_mask:0xf
    v_max_f32_dpp v32, v32, v32 quad_perm:[2,3,0,1] row_mask:0xf bank_mask:0xf
    v_max_f32_dpp v33, v33, v33 quad_perm:[2,3,0,1] row_mask:0xf bank_mask:0xf
    v_max_f32_dpp v34, v34, v34 quad_perm:[2,3,0,1] row_mask:0xf bank_mask:0xf
    v_max_f32_dpp v35, v35, v35 quad_perm:[2,3,0,1] row_mask:0xf bank_mask:0xf
    v_max_f32_dpp v32, v32, v32 row_half_mirror row_mask:0xf bank_mask:0xf
    v_max_f32_dpp v33, v33, v33 row_half_mirror row_mask:0xf bank_mask:0xf
    v_max_f32_dpp v34, v34, v34 row_half_mirror row_mask:0xf bank_mask:0xf
    v_max_f32_dpp v35, v35, v35 row_half_mirror row_mask:0xf bank_mask:0xf
    v_max3_f32 v36, v32, v33, v34
    v_max_f32 v36, v36, v35
    s_nop 1
    v_max_f32_dpp v36, v36, v36 row_mirror row_mask:0xf bank_mask:0xf
    v_mov_b32 v37, v36
    s_nop 1
    v_permlane16_swap_b32 v36, v37
    v_max_f32 v36, v36, v37
    v_mov_b32 v37, v36
    s_nop 1
    v_permlane32_swap_b32 v36, v37
    v_max_f32 v36, v36, v37
    v_sub_f32 v108, v108, v36
    v_sub_f32 v32, v32, v36
    v_sub_f32 v112, v112, v36
    v_sub_f32 v33, v33, v36
    v_sub_f32 v116, v116, v36
    v_sub_f32 v34, v34, v36
    v_sub_f32 v120, v120, v36
    v_sub_f32 v35, v35, v36
    v_exp_f32 v108, v108
    v_exp_f32 v32, v32
    v_exp_f32 v112, v112
    v_exp_f32 v33, v33
    v_exp_f32 v116, v116
    v_exp_f32 v34, v34
    v_exp_f32 v120, v120
    v_exp_f32 v35, v35
    v_mul_f32 v38, v108, v109
    v_fmac_f32 v38, v112, v113
    v_fmac_f32 v38, v116, v117
    v_fmac_f32 v38, v120, v121
    v_cvt_pk_bf16_f32 v32, v32, v32
    v_cvt_pk_bf16_f32 v33, v33, v33
    v_cvt_pk_bf16_f32 v34, v34, v34
    v_cvt_pk_bf16_f32 v35, v35, v35
    v_add_f32_dpp v38, v38, v38 quad_perm:[1,0,3,2] row_mask:0xf bank_mask:0xf
    s_nop 1
    v_add_f32_dpp v38, v38, v38 quad_perm:[2,3,0,1] row_mask:0xf bank_mask:0xf
    s_nop 1
    v_add_f32_dpp v38, v38, v38 row_half_mirror row_mask:0xf bank_mask:0xf
    s_nop 1
    v_add_f32_dpp v38, v38, v38 row_mirror row_mask:0xf bank_mask:0xf
    v_mov_b32 v37, v38
    s_nop 1
    v_permlane16_swap_b32 v38, v37
    v_add_f32 v38, v38, v37
    v_mov_b32 v37, v38
    s_nop 1
    v_permlane32_swap_b32 v38, v37
    v_add_f32 v38, v38, v37
    v_rcp_f32 v38, v38
    ds_write_b128 v23, v[32:35]
    ds_write_b32 v23, v38 offset:1024
    ds_add_u32 v1, v2 offset:5376
    s_cmp_lt_u32 s38, 5
    s_cbranch_scc1 L_w7e
    s_cmp_lt_u32 s41, 10
    s_cbranch_scc0 L_fin
L_ffn2:
    v_bfe_u32 v3, v0, 2, 3
    v_lshlrev_b32 v8, 7, v3
    v_lshrrev_b32 v3, 1, v3
    v_lshl_add_u32 v8, v3, 5, v8
    v_and_b32 v3, 3, v0
    v_lshl_add_u32 v8, v3, 3, v8
    s_and_b32 s52, s34, 1
    s_lshl_b32 s55, s52, 6
    v_lshrrev_b32 v6, 5, v0
    v_lshl_add_u32 v8, v6, 11, v8
    v_xor_b32 v8, s55, v8
    v_add_u32 v200, 49152, v8
    v_xor_b32 v201, 32, v200
    v_lshlrev_b32 v184, 4, v5
    v_add_u32 v184, 141312, v184
    s_lshr_b32 s55, s35, 2
    s_mul_i32 s55, s55, 22528
    s_mul_i32 s54, s35, 2560
    s_add_u32 s54, s54, s55
    s_lshl_b32 s55, s41, 8
    s_add_u32 s54, s54, s55
    s_lshl_b32 s55, s52, 7
    s_add_u32 s54, s54, s55
    s_add_u32 s54, s54, 2359296
    s_movk_i32 s19, 298
WF_63:
    ds_read_b32 v3, v1 offset:6912
    s_waitcnt lgkmcnt(0)
    v_cmp_gt_u32 vcc, 1, v3
    s_cbranch_vccnz WF_63
    s_branch L_s6go
L_w7e:
WF_64:
    ds_read_b32 v3, v1 offset:3840
    s_waitcnt lgkmcnt(0)
    v_cmp_gt_u32 vcc, 3, v3
    s_cbranch_vccnz WF_64
L_ge:
GE_65:
    s_sub_u32 s42, s42, 1
    s_cbranch_scc1 GU_66
    buffer_load_dwordx4 v[32:35], v24, s[28:31], s52 offen offset:0 sc1
    buffer_load_dwordx4 v[36:39], v24, s[28:31], s52 offen offset:256 sc1
    buffer_load_dwordx4 v[40:43], v24, s[28:31], s52 offen offset:512 sc1
    buffer_load_dwordx4 v[44:47], v24, s[28:31], s53 offen offset:0 sc1
    buffer_load_dwordx4 v[48:51], v24, s[28:31], s53 offen offset:256 sc1
    buffer_load_dwordx4 v[52:55], v24, s[28:31], s53 offen offset:512 sc1
    s_waitcnt vmcnt(5)
    v_mfma_f32_16x16x16_bf16 v[72:75], v[16:17], v[32:33], 0
    s_waitcnt vmcnt(4)
    v_mfma_f32_16x16x16_bf16 v[72:75], v[18:19], v[36:37], v[72:75]
    s_waitcnt vmcnt(3)
    v_mfma_f32_16x16x16_bf16 v[72:75], v[20:21], v[40:41], v[72:75]
    s_waitcnt vmcnt(2)
    v_mfma_f32_16x16x16_bf16 v[72:75], v[16:17], v[44:45], v[72:75]
    s_waitcnt vmcnt(1)
    v_mfma_f32_16x16x16_bf16 v[72:75], v[18:19], v[48:49], v[72:75]
    s_waitcnt vmcnt(0)
    v_mfma_f32_16x16x16_bf16 v[72:75], v[20:21], v[52:53], v[72:75]
    v_cmpx_eq_u64 vcc, s[48:49], v[34:35]
    v_cmpx_eq_u64 vcc, s[48:49], v[38:39]
    v_cmpx_eq_u64 vcc, s[48:49], v[42:43]
    v_cmpx_eq_u64 vcc, s[48:49], v[46:47]
    v_cmpx_eq_u64 vcc, s[48:49], v[50:51]
    v_cmpx_eq_u64 vcc, s[48:49], v[54:55]
    s_cmp_eq_u64 exec, -1
    s_mov_b64 exec, -1
    s_cbranch_scc0 GE_65
OK_67:
    s_mov_b32 exec_hi, 0xffff
    v_cvt_pk_bf16_f32 v72, v72, v73
    v_cvt_pk_bf16_f32 v73, v74, v75
    ds_write_b64 v26, v[72:73]
    s_mov_b64 exec, -1
    ds_add_u32 v1, v2 offset:2048
    s_branch L_fin
L_w5:
    v_lshlrev_b32 v6, 4, v0
    v_mov_b32 v8, -1
    v_mov_b32 v9, -1
    v_mov_b32 v10, -1
    v_mov_b32 v11, -1
    s_mul_i32 s52, s39, 12032
    s_add_u32 s52, s52, 4194304
    s_add_u32 s53, s52, 8192
    v_lshlrev_b32 v22, 6, v0
    v_add_u32 v7, s53, v22
    s_mov_b32 exec_lo, 0
    s_mov_b32 exec_hi, 268369920
    buffer_load_dword v23, v7, s[28:31], 0 offen sc1
    s_mov_b64 exec, -1
    s_lshr_b32 s55, s37, 2
    s_mul_i32 s55, s55, 22528
    s_mul_i32 s57, s37, 2560
    s_add_u32 s57, s57, s55
    s_lshl_b32 s55, s38, 9
    s_add_u32 s57, s57, s55
    s_add_u32 s57, s57, 2097152
    s_mov_b32 s58, -1
    s_mov_b32 s59, 0
    s_cmp_lt_u32 s38, 5
    s_cbranch_scc1 L_g3
    s_lshr_b32 s55, s35, 2
    s_mul_i32 s55, s55, 22528
    s_mul_i32 s57, s35, 2560
    s_add_u32 s57, s57, s55
    s_lshl_b32 s55, s41, 8
    s_add_u32 s57, s57, s55
    s_add_u32 s57, s57, 2359296
    s_mov_b32 s58, 0xffff
    s_cmp_lt_u32 s41, 10
    s_cselect_b32 s57, s57, 12582912
L_g3:
    s_setprio 2
    v_and_b32 v7, 1, v4
    v_lshlrev_b32 v7, 4, v7
    v_mov_b32 v16, 0xffff
    v_lshlrev_b32 v7, v7, v16
    v_lshrrev_b32 v16, 1, v4
    v_cmp_eq_u32 vcc, 0, v16
    s_nop 1
    v_cndmask_b32 v12, 0, v7, vcc
    v_cmp_eq_u32 vcc, 2, v16
    s_nop 1
    v_cndmask_b32 v13, 0, v7, vcc
    v_cmp_eq_u32 vcc, 4, v16
    s_nop 1
    v_cndmask_b32 v14, 0, v7, vcc
    v_mov_b32 v43, 0
    v_mov_b32 v47, 0
    v_mov_b32 v51, 0
    v_mov_b32 v55, 0
    v_mov_b32 v59, 0
    v_mov_b32 v63, 0
    v_mov_b32 v67, 0
    v_mov_b32 v71, 0
    v_bfe_u32 v7, v4, 2, 1
    v_mad_u32_u24 v7, v7, 3, v5
    v_lshrrev_b32 v17, 3, v4
    v_lshlrev_b32 v18, 6, v17
    v_lshl_add_u32 v18, v7, 2, v18
    v_lshlrev_b32 v19, 3, v17
    v_lshl_add_u32 v19, v7, 2, v19
    v_add_u32 v19, 112, v19
    v_cmp_gt_u32 vcc, 4, v7
    s_nop 1
    v_cndmask_b32 v18, v19, v18, vcc
    v_and_b32 v7, 3, v4
    v_lshl_add_u32 v18, v7, 4, v18
    v_add_u32 v18, 141632, v18
    s_movk_i32 s55, 1024
    v_lshlrev_b32 v16, 7, v0
    s_waitcnt lgkmcnt(0)
    s_add_u32 s32, s32, 0x7f4a7c10
    s_addc_u32 s33, s33, 0x9e3779b9
    s_or_b32 s32, s32, 15
WF_68:
    ds_read_b32 v3, v1 offset:0
    s_waitcnt lgkmcnt(0)
    v_cmp_gt_u32 vcc, 88, v3
    s_cbranch_vccnz WF_68
    s_cmp_lt_u32 s41, 10
    s_cselect_b32 exec_hi, 0xfff3, 3
    buffer_load_dword v23, v22, s[28:31], s53 offen sc1
    s_mov_b64 exec, -1
    s_waitcnt vmcnt(0)
    buffer_store_dwordx4 v[8:11], v6, s[28:31], s53 offen
    buffer_store_dwordx4 v[8:11], v6, s[28:31], s53 offen offset:1024
    s_mov_b64 exec, 0xff
    buffer_store_dwordx4 v[8:11], v6, s[28:31], s53 offen offset:2048
    s_mov_b64 exec, -1
WF_69:
    ds_read_b32 v3, v1 offset:0
    s_waitcnt lgkmcnt(0)
    v_cmp_gt_u32 vcc, 94, v3
    s_cbranch_vccnz WF_69
FL_70:
    s_sub_u32 s42, s42, 1
    s_cbranch_scc1 GU_71
    s_mov_b64 exec, 0xff
    buffer_load_dwordx2 v[24:25], v16, s[28:31], s55 offen sc1
    s_waitcnt vmcnt(0)
    v_cmp_ne_u64 vcc, s[32:33], v[24:25]
    s_mov_b64 exec, -1
    s_cbranch_vccnz FL_70
OK_72:
    ds_add_u32 v1, v2 offset:1024
    s_lshr_b32 s55, s38, 2
    s_mul_i32 s55, s55, 0
    s_mul_i32 s52, s38, 12032
    s_add_u32 s52, s52, s55
    s_mul_i32 s55, s37, 96256
    s_add_u32 s52, s52, s55
    s_add_u32 s52, s52, 4194304
    s_add_u32 s53, s52, 4096
    v_add_u32 v20, 137216, v6
    s_and_b32 s56, s32, 0xbfffbfff
    v_lshlrev_b32 v7, 9, v5
    v_lshl_add_u32 v7, v4, 3, v7
    v_add_u32 v7, 142592, v7
    v_lshrrev_b32 v17, 2, v0
    v_mul_u32_u24 v17, 131072, v17
    v_and_b32 v19, 3, v0
    v_lshl_add_u32 v17, v19, 4, v17
    s_lshr_b32 s60, s39, 6
    s_mul_i32 s54, s60, 32768
    s_and_b32 s55, s39, 63
    s_lshl_b32 s55, s55, 6
    s_add_u32 s54, s54, s55
    s_add_u32 s54, s54, 1048576
    v_mov_b32 v26, s32
    v_mov_b32 v27, s33
WF_73:
    ds_read_b32 v3, v1 offset:3328
    s_waitcnt lgkmcnt(0)
    v_cmp_gt_u32 vcc, 2, v3
    s_cbranch_vccnz WF_73
    s_mov_b32 exec_hi, 0
    ds_read_b64 v[24:25], v7
    ds_read_b32 v28, v7 offset:132
    ds_read_b32 v29, v7 offset:260
    ds_read_b32 v30, v7 offset:388
    s_waitcnt lgkmcnt(0)
    v_add_f32 v25, v25, v28
    v_add_f32 v29, v29, v30
    v_add_f32 v25, v25, v29
    buffer_store_dwordx4 v[24:27], v17, s[28:31], s54 offen sc1
    s_mov_b64 exec, -1
    s_mov_b64 exec, s[58:59]
    buffer_store_dwordx4 v[8:11], v6, s[28:31], s57 offen sc1
    s_mov_b64 exec, -1
    s_waitcnt vmcnt(0)
    ds_add_u32 v1, v2 offset:6912
WF_74:
    ds_read_b32 v3, v1 offset:3584
    s_waitcnt lgkmcnt(0)
    v_cmp_gt_u32 vcc, 4, v3
    s_cbranch_vccnz WF_74
WF_75:
    ds_read_b32 v3, v1 offset:5376
    s_waitcnt lgkmcnt(0)
    v_cmp_gt_u32 vcc, 1, v3
    s_cbranch_vccnz WF_75
L_cdgo:
    buffer_load_dwordx4 v[72:75], v6, s[28:31], s52 offen offset:0 sc1
    buffer_load_dwordx4 v[76:79], v6, s[28:31], s52 offen offset:1024 sc1
    buffer_load_dwordx4 v[80:83], v6, s[28:31], s52 offen offset:2048 sc1
    buffer_load_dwordx4 v[84:87], v6, s[28:31], s52 offen offset:3072 sc1
    buffer_load_dwordx4 v[88:91], v6, s[28:31], s53 offen offset:0 sc1
    buffer_load_dwordx4 v[92:95], v6, s[28:31], s53 offen offset:1024 sc1
    buffer_load_dwordx4 v[96:99], v6, s[28:31], s53 offen offset:2048 sc1
    buffer_load_dwordx4 v[100:103], v6, s[28:31], s53 offen offset:3072 sc1
    ds_add_u32 v1, v2 offset:5120
SW_76:
    ds_read_b32 v3, v1 offset:5376
    ds_read_b128 v[32:35], v20
    ds_read_b32 v38, v20 offset:1024
    s_waitcnt lgkmcnt(0)
    v_cmp_gt_u32 vcc, 1, v3
    s_cbranch_vccnz SW_76
    v_and_b32_dpp v40, v32, v12 row_newbcast:0 row_mask:0xf bank_mask:0xf
    v_and_b32_dpp v41, v32, v13 row_newbcast:0 row_mask:0xf bank_mask:0xf
    v_and_b32_dpp v42, v32, v14 row_newbcast:0 row_mask:0xf bank_mask:0xf
    v_and_b32_dpp v44, v32, v12 row_newbcast:8 row_mask:0xf bank_mask:0xf
    v_and_b32_dpp v45, v32, v13 row_newbcast:8 row_mask:0xf bank_mask:0xf
    v_and_b32_dpp v46, v32, v14 row_newbcast:8 row_mask:0xf bank_mask:0xf
    v_and_b32_dpp v48, v33, v12 row_newbcast:0 row_mask:0xf bank_mask:0xf
    v_and_b32_dpp v49, v33, v13 row_newbcast:0 row_mask:0xf bank_mask:0xf
    v_and_b32_dpp v50, v33, v14 row_newbcast:0 row_mask:0xf bank_mask:0xf
    v_and_b32_dpp v52, v33, v12 row_newbcast:8 row_mask:0xf bank_mask:0xf
    v_and_b32_dpp v53, v33, v13 row_newbcast:8 row_mask:0xf bank_mask:0xf
    v_and_b32_dpp v54, v33, v14 row_newbcast:8 row_mask:0xf bank_mask:0xf
    v_and_b32_dpp v56, v34, v12 row_newbcast:0 row_mask:0xf bank_mask:0xf
    v_and_b32_dpp v57, v34, v13 row_newbcast:0 row_mask:0xf bank_mask:0xf
    v_and_b32_dpp v58, v34, v14 row_newbcast:0 row_mask:0xf bank_mask:0xf
    v_and_b32_dpp v60, v34, v12 row_newbcast:8 row_mask:0xf bank_mask:0xf
    v_and_b32_dpp v61, v34, v13 row_newbcast:8 row_mask:0xf bank_mask:0xf
    v_and_b32_dpp v62, v34, v14 row_newbcast:8 row_mask:0xf bank_mask:0xf
    v_and_b32_dpp v64, v35, v12 row_newbcast:0 row_mask:0xf bank_mask:0xf
    v_and_b32_dpp v65, v35, v13 row_newbcast:0 row_mask:0xf bank_mask:0xf
    v_and_b32_dpp v66, v35, v14 row_newbcast:0 row_mask:0xf bank_mask:0xf
    v_and_b32_dpp v68, v35, v12 row_newbcast:8 row_mask:0xf bank_mask:0xf
    v_and_b32_dpp v69, v35, v13 row_newbcast:8 row_mask:0xf bank_mask:0xf
    v_and_b32_dpp v70, v35, v14 row_newbcast:8 row_mask:0xf bank_mask:0xf
    v_mov_b32 v39, v38
    s_branch L_cdm
CD_77:
    s_sub_u32 s42, s42, 1
    s_cbranch_scc1 GU_78
    buffer_load_dwordx4 v[72:75], v6, s[28:31], s52 offen offset:0 sc1
    buffer_load_dwordx4 v[76:79], v6, s[28:31], s52 offen offset:1024 sc1
    buffer_load_dwordx4 v[80:83], v6, s[28:31], s52 offen offset:2048 sc1
    buffer_load_dwordx4 v[84:87], v6, s[28:31], s52 offen offset:3072 sc1
    buffer_load_dwordx4 v[88:91], v6, s[28:31], s53 offen offset:0 sc1
    buffer_load_dwordx4 v[92:95], v6, s[28:31], s53 offen offset:1024 sc1
    buffer_load_dwordx4 v[96:99], v6, s[28:31], s53 offen offset:2048 sc1
    buffer_load_dwordx4 v[100:103], v6, s[28:31], s53 offen offset:3072 sc1
L_cdm:
    s_waitcnt vmcnt(7)
    v_mfma_f32_16x16x32_bf16 v[104:107], v[40:43], v[72:75], 0
    s_waitcnt vmcnt(6)
    v_mfma_f32_16x16x32_bf16 v[104:107], v[44:47], v[76:79], v[104:107]
    s_waitcnt vmcnt(5)
    v_mfma_f32_16x16x32_bf16 v[104:107], v[48:51], v[80:83], v[104:107]
    s_waitcnt vmcnt(4)
    v_mfma_f32_16x16x32_bf16 v[104:107], v[52:55], v[84:87], v[104:107]
    s_waitcnt vmcnt(3)
    v_mfma_f32_16x16x32_bf16 v[104:107], v[56:59], v[88:91], v[104:107]
    s_waitcnt vmcnt(2)
    v_mfma_f32_16x16x32_bf16 v[104:107], v[60:63], v[92:95], v[104:107]
    s_waitcnt vmcnt(1)
    v_mfma_f32_16x16x32_bf16 v[104:107], v[64:67], v[96:99], v[104:107]
    s_waitcnt vmcnt(0)
    v_mfma_f32_16x16x32_bf16 v[104:107], v[68:71], v[100:103], v[104:107]
    v_cmpx_eq_u32 vcc, s56, v75
    v_cmpx_eq_u32 vcc, s56, v79
    v_cmpx_eq_u32 vcc, s56, v83
    v_cmpx_eq_u32 vcc, s56, v87
    v_cmpx_eq_u32 vcc, s56, v91
    v_cmpx_eq_u32 vcc, s56, v95
    v_cmpx_eq_u32 vcc, s56, v99
    v_cmpx_eq_u32 vcc, s56, v103
    s_cmp_eq_u64 exec, -1
    s_mov_b64 exec, -1
    s_cbranch_scc0 CD_77
OK_79:
    s_mov_b32 exec_hi, 0xffff
    v_pk_mul_f32 v[104:105], v[104:105], v[38:39]
    v_cvt_pk_bf16_f32 v104, v104, v105
    ds_write_b32 v18, v104
    s_mov_b64 exec, -1
    ds_add_u32 v1, v2 offset:1792
    s_branch L_fin
L_w6:
    v_lshlrev_b32 v6, 2, v0
    v_add_u32 v6, 137216, v6
    s_mul_i32 s52, s38, 160
    s_min_u32 s53, s41, 9
    s_lshl_b32 s53, s53, 7
    s_sub_u32 s53, s53, 256
    v_mov_b32 v16, s52
    v_mov_b32 v13, s53
    v_cmp_gt_u32 vcc, 32, v0
    s_nop 1
    v_cndmask_b32 v16, v13, v16, vcc
    v_lshl_add_u32 v16, v0, 3, v16
    v_add_u32 v16, 137216, v16
    v_bfe_u32 v7, v0, 3, 2
    v_lshlrev_b32 v27, 6, v7
    v_and_b32 v7, 3, v0
    v_lshl_add_u32 v27, v7, 4, v27
    v_bfe_u32 v7, v0, 2, 1
    v_lshl_add_u32 v27, v7, 3, v27
    v_lshrrev_b32 v7, 5, v0
    v_mul_u32_u24 v7, 192, v7
    v_add_u32 v27, v27, v7
    v_add_u32 v27, 141312, v27
    s_mov_b32 s54, 0xffff0000
WF_80:
    ds_read_b32 v3, v1 offset:0
    s_waitcnt lgkmcnt(0)
    v_cmp_gt_u32 vcc, 64, v3
    s_cbranch_vccnz WF_80
    ds_read_b32 v8, v6 offset:0
    ds_read_b32 v9, v6 offset:256
    ds_read_b32 v10, v6 offset:512
    ds_read_b32 v11, v6 offset:768
    ds_read_b32 v12, v6 offset:1024
    ds_read_b64 v[14:15], v16
    s_waitcnt lgkmcnt(0)
    v_lshlrev_b32 v32, 16, v8
    v_and_b32 v33, s54, v8
    v_lshlrev_b32 v34, 16, v9
    v_and_b32 v35, s54, v9
    v_lshlrev_b32 v36, 16, v10
    v_and_b32 v37, s54, v10
    v_lshlrev_b32 v38, 16, v11
    v_and_b32 v39, s54, v11
    v_lshlrev_b32 v40, 16, v12
    v_and_b32 v41, s54, v12
    v_pk_add_f32 v[44:45], v[32:33], v[34:35]
    v_pk_add_f32 v[46:47], v[36:37], v[38:39]
    v_pk_add_f32 v[44:45], v[44:45], v[40:41]
    v_pk_add_f32 v[44:45], v[44:45], v[46:47]
    v_add_f32 v44, v44, v45
    s_nop 1
    v_add_f32_dpp v44, v44, v44 quad_perm:[1,0,3,2] row_mask:0xf bank_mask:0xf
    s_nop 1
    v_add_f32_dpp v44, v44, v44 quad_perm:[2,3,0,1] row_mask:0xf bank_mask:0xf
    s_nop 1
    v_add_f32_dpp v44, v44, v44 row_half_mirror row_mask:0xf bank_mask:0xf
    s_nop 1
    v_add_f32_dpp v44, v44, v44 row_mirror row_mask:0xf bank_mask:0xf
    v_mov_b32 v45, v44
    s_nop 1
    v_permlane16_swap_b32 v44, v45
    v_add_f32 v44, v44, v45
    v_mov_b32 v45, v44
    s_nop 1
    v_permlane32_swap_b32 v44, v45
    v_add_f32 v44, v44, v45
    v_mul_f32 v44, 0x3acccccd, v44
    v_sub_f32 v32, v32, v44
    v_sub_f32 v33, v33, v44
    v_sub_f32 v34, v34, v44
    v_sub_f32 v35, v35, v44
    v_sub_f32 v36, v36, v44
    v_sub_f32 v37, v37, v44
    v_sub_f32 v38, v38, v44
    v_sub_f32 v39, v39, v44
    v_sub_f32 v40, v40, v44
    v_sub_f32 v41, v41, v44
    v_mul_f32 v46, v32, v32
    v_fmac_f32 v46, v33, v33
    v_fmac_f32 v46, v34, v34
    v_fmac_f32 v46, v35, v35
    v_fmac_f32 v46, v36, v36
    v_fmac_f32 v46, v37, v37
    v_fmac_f32 v46, v38, v38
    v_fmac_f32 v46, v39, v39
    v_fmac_f32 v46, v40, v40
    v_fmac_f32 v46, v41, v41
    s_nop 1
    v_add_f32_dpp v46, v46, v46 quad_perm:[1,0,3,2] row_mask:0xf bank_mask:0xf
    s_nop 1
    v_add_f32_dpp v46, v46, v46 quad_perm:[2,3,0,1] row_mask:0xf bank_mask:0xf
    s_nop 1
    v_add_f32_dpp v46, v46, v46 row_half_mirror row_mask:0xf bank_mask:0xf
    s_nop 1
    v_add_f32_dpp v46, v46, v46 row_mirror row_mask:0xf bank_mask:0xf
    v_mov_b32 v45, v46
    s_nop 1
    v_permlane16_swap_b32 v46, v45
    v_add_f32 v46, v46, v45
    v_mov_b32 v45, v46
    s_nop 1
    v_permlane32_swap_b32 v46, v45
    v_add_f32 v46, v46, v45
    v_mul_f32 v46, 0x3acccccd, v46
    v_cvt_pk_bf16_f32 v46, v46, v46
    v_and_b32 v46, s54, v46
    v_cvt_pk_bf16_f32 v44, v44, v44
    v_and_b32 v44, s54, v44
    v_add_f32 v46, 0x3727c5ac, v46
    v_cvt_pk_bf16_f32 v46, v46, v46
    v_and_b32 v46, s54, v46
    v_sqrt_f32 v46, v46
    s_nop 0
    v_cvt_pk_bf16_f32 v46, v46, v46
    v_and_b32 v46, s54, v46
    v_rcp_f32 v46, v46
    v_lshlrev_b32 v32, 16, v14
    v_and_b32 v33, s54, v14
    v_lshlrev_b32 v34, 16, v15
    v_and_b32 v35, s54, v15
    v_sub_f32 v32, v32, v44
    v_sub_f32 v33, v33, v44
    v_sub_f32 v34, v34, v44
    v_sub_f32 v35, v35, v44
    v_cvt_pk_bf16_f32 v14, v32, v33
    v_cvt_pk_bf16_f32 v15, v34, v35
    v_lshlrev_b32 v32, 16, v14
    v_and_b32 v33, s54, v14
    v_lshlrev_b32 v34, 16, v15
    v_and_b32 v35, s54, v15
    v_mul_f32 v32, v32, v46
    v_mul_f32 v33, v33, v46
    v_mul_f32 v34, v34, v46
    v_mul_f32 v35, v35, v46
    v_cvt_pk_bf16_f32 v14, v32, v33
    v_cvt_pk_bf16_f32 v15, v34, v35
    s_mov_b32 exec_lo, 0x000fffff
    s_mov_b32 exec_hi, 0xffff
    ds_write_b64 v27, v[14:15]
    s_mov_b64 exec, -1
    ds_add_u32 v1, v2 offset:512
    s_waitcnt lgkmcnt(0)
    s_add_u32 s32, s32, 0x7f4a7c10
    s_addc_u32 s33, s33, 0x9e3779b9
    s_or_b32 s32, s32, 15
L_w6b:
    s_mov_b32 s54, 0xffff0000
    s_cmp_lt_u32 s2, 20
    s_cbranch_scc1 L_final
    s_cmp_lt_u32 s41, 10
    s_cbranch_scc0 L_fin
    s_mov_b32 s56, 65537
    s_mov_b32 s57, 65537
    s_mov_b32 s58, 131074
    s_mov_b32 s59, 131074
    s_mov_b32 s60, 262148
    s_mov_b32 s61, 262148
    s_mov_b32 s62, 524296
    s_mov_b32 s63, 524296
    s_mov_b32 s44, s20
    s_mov_b32 s45, s21
    s_mov_b32 s46, 3072
    s_mov_b32 s47, 0x20000
    v_lshlrev_b32 v8, 7, v5
    v_and_b32 v6, 3, v4
    v_lshl_add_u32 v8, v6, 5, v8
    v_lshrrev_b32 v6, 2, v4
    v_lshl_add_u32 v8, v6, 3, v8
    s_mul_i32 s52, s35, 384
    v_add_u32 v86, s52, v8
    buffer_load_dwordx2 v[22:23], v86, s[44:47], 0 offen
    v_mul_u32_u24 v24, 96256, v5
    v_lshl_add_u32 v24, v4, 4, v24
    v_and_b32 v6, 1, v4
    v_lshlrev_b32 v6, 4, v6
    v_mov_b32 v7, 0x3f80
    v_lshlrev_b32 v6, v6, v7
    v_lshrrev_b32 v7, 1, v4
    v_cmp_eq_u32 vcc, 0, v7
    s_nop 1
    v_cndmask_b32 v16, 0, v6, vcc
    v_cmp_eq_u32 vcc, 1, v7
    s_nop 1
    v_cndmask_b32 v17, 0, v6, vcc
    v_cmp_eq_u32 vcc, 2, v7
    s_nop 1
    v_cndmask_b32 v18, 0, v6, vcc
    v_cmp_eq_u32 vcc, 3, v7
    s_nop 1
    v_cndmask_b32 v19, 0, v6, vcc
    v_cmp_eq_u32 vcc, 4, v7
    s_nop 1
    v_cndmask_b32 v20, 0, v6, vcc
    v_cmp_eq_u32 vcc, 5, v7
    s_nop 1
    v_cndmask_b32 v21, 0, v6, vcc
    v_lshlrev_b32 v26, 7, v5
    v_bfe_u32 v6, v4, 1, 1
    v_lshl_add_u32 v26, v6, 6, v26
    v_lshrrev_b32 v6, 2, v4
    v_lshl_add_u32 v26, v6, 4, v26
    v_and_b32 v6, 1, v4
    v_lshl_add_u32 v26, v6, 3, v26
    v_add_u32 v26, 142208, v26
    v_lshlrev_b32 v28, 4, v0
    s_mul_i32 s40, s39, 12032
    s_add_u32 s40, s40, 4202496
    s_mov_b32 s48, s32
    s_mov_b32 s49, s33
    s_getreg_b32 s50, hwreg(HW_REG_XCC_ID, 0, 4)
    s_xor_b32 s50, s50, s32
    v_bfe_u32 v3, v0, 2, 3
    v_lshlrev_b32 v80, 7, v3
    v_lshrrev_b32 v3, 1, v3
    v_lshl_add_u32 v80, v3, 5, v80
    v_and_b32 v3, 3, v0
    v_lshl_add_u32 v80, v3, 3, v80
    v_lshrrev_b32 v6, 5, v0
    v_mul_u32_u24 v6, 3072, v6
    v_add_u32 v80, v80, v6
    v_add_u32 v80, 100352, v80
    v_xor_b32 v81, 32, v80
    v_xor_b32 v82, 64, v80
    v_xor_b32 v83, 96, v80
    v_lshlrev_b32 v84, 6, v5
    v_lshl_add_u32 v84, v4, 4, v84
    v_lshlrev_b32 v85, 4, v5
    v_add_u32 v85, 141504, v85
    ds_read_b128 v[88:91], v85
    ds_read_b128 v[92:95], v85 offset:64
    v_mov_b32 v78, s50
    v_mov_b32 v79, s49
    v_mov_b32 v56, 0
    v_mov_b32 v57, 0
    v_mov_b32 v59, s49
    v_mov_b32 v60, 0
    v_mov_b32 v61, 0
    v_mov_b32 v63, s49
    v_mov_b32 v64, 0
    v_mov_b32 v65, 0
    v_mov_b32 v67, s49
    s_mul_i32 s52, s35, 385024
    s_add_u32 s52, s52, 4264960
    s_add_u32 s53, s52, 12032
    s_add_u32 s51, s53, 12032
    s_add_u32 s55, s40, 2304
    s_mov_b32 s43, 0
WF_81:
    ds_read_b32 v3, v1 offset:0
    s_waitcnt lgkmcnt(0)
    v_cmp_gt_u32 vcc, 250, v3
    s_cbranch_vccnz WF_81
    ds_read_b64_tr_b16 v[96:97], v80 offset:0
    ds_read_b64_tr_b16 v[98:99], v80 offset:6144
    ds_read_b64_tr_b16 v[100:101], v80 offset:12288
    ds_read_b64_tr_b16 v[102:103], v80 offset:18432
    ds_read_b64_tr_b16 v[104:105], v81 offset:0
    ds_read_b64_tr_b16 v[106:107], v81 offset:6144
    ds_read_b64_tr_b16 v[108:109], v81 offset:12288
    ds_read_b64_tr_b16 v[110:111], v81 offset:18432
    ds_read_b64_tr_b16 v[112:113], v82 offset:0
    ds_read_b64_tr_b16 v[114:115], v82 offset:6144
    ds_read_b64_tr_b16 v[116:117], v82 offset:12288
    ds_read_b64_tr_b16 v[118:119], v82 offset:18432
    ds_read_b64_tr_b16 v[120:121], v83 offset:0
    ds_read_b64_tr_b16 v[122:123], v83 offset:6144
    ds_read_b64_tr_b16 v[124:125], v83 offset:12288
    ds_read_b64_tr_b16 v[126:127], v83 offset:18432
F1_82:
    v_add_u32 v80, 1024, v80
    s_waitcnt lgkmcnt(12)
    v_mfma_f32_16x16x32_bf16 v[128:131], v[96:99], v[88:91], 0
    v_mfma_f32_16x16x32_bf16 v[128:131], v[100:103], v[92:95], v[128:131]
    v_add_u32 v81, 1024, v81
    s_waitcnt lgkmcnt(8)
    v_mfma_f32_16x16x32_bf16 v[132:135], v[104:107], v[88:91], 0
    v_mfma_f32_16x16x32_bf16 v[132:135], v[108:111], v[92:95], v[132:135]
    v_add_u32 v82, 1024, v82
    s_waitcnt lgkmcnt(4)
    v_mfma_f32_16x16x32_bf16 v[136:139], v[112:115], v[88:91], 0
    v_mfma_f32_16x16x32_bf16 v[136:139], v[116:119], v[92:95], v[136:139]
    v_add_u32 v83, 1024, v83
    s_waitcnt lgkmcnt(0)
    v_mfma_f32_16x16x32_bf16 v[140:143], v[120:123], v[88:91], 0
    v_mfma_f32_16x16x32_bf16 v[140:143], v[124:127], v[92:95], v[140:143]
    ds_read_b64_tr_b16 v[96:97], v80 offset:0
    ds_read_b64_tr_b16 v[98:99], v80 offset:6144
    ds_read_b64_tr_b16 v[100:101], v80 offset:12288
    ds_read_b64_tr_b16 v[102:103], v80 offset:18432
    ds_read_b64_tr_b16 v[104:105], v81 offset:0
    ds_read_b64_tr_b16 v[106:107], v81 offset:6144
    ds_read_b64_tr_b16 v[108:109], v81 offset:12288
    ds_read_b64_tr_b16 v[110:111], v81 offset:18432
    ds_read_b64_tr_b16 v[112:113], v82 offset:0
    ds_read_b64_tr_b16 v[114:115], v82 offset:6144
    ds_read_b64_tr_b16 v[116:117], v82 offset:12288
    ds_read_b64_tr_b16 v[118:119], v82 offset:18432
    ds_read_b64_tr_b16 v[120:121], v83 offset:0
    ds_read_b64_tr_b16 v[122:123], v83 offset:6144
    ds_read_b64_tr_b16 v[124:125], v83 offset:12288
    ds_read_b64_tr_b16 v[126:127], v83 offset:18432
    s_mov_b64 exec, s[56:57]
    v_cvt_pk_bf16_f32 v76, v128, v129
    v_cvt_pk_bf16_f32 v77, v130, v131
    s_mov_b64 exec, s[58:59]
    v_cvt_pk_bf16_f32 v76, v132, v133
    v_cvt_pk_bf16_f32 v77, v134, v135
    s_mov_b64 exec, s[60:61]
    v_cvt_pk_bf16_f32 v76, v136, v137
    v_cvt_pk_bf16_f32 v77, v138, v139
    s_mov_b64 exec, s[62:63]
    v_cvt_pk_bf16_f32 v76, v140, v141
    v_cvt_pk_bf16_f32 v77, v142, v143
    s_mov_b32 exec_lo, 0x000f000f
    s_mov_b32 exec_hi, 0x000f000f
    buffer_store_dwordx4 v[76:79], v84, s[28:31], s55 offen offset:0
    s_mov_b64 exec, -1
    s_add_u32 s55, s55, 256
    s_add_u32 s43, s43, 1
    s_cmp_lt_u32 s43, 3
    s_cbranch_scc1 F1_82
    s_mov_b32 s58, s50
    s_mov_b32 s59, s49
    s_mov_b32 s61, s40
WF_83:
    ds_read_b32 v3, v1 offset:2304
    s_waitcnt lgkmcnt(0)
    v_cmp_gt_u32 vcc, 4, v3
    s_cbranch_vccnz WF_83
    s_andn2_b32 s42, s42, 15
GH_84:
    s_sub_u32 s42, s42, 1
    s_cbranch_scc1 GU_85
    v_mov_b32 v58, s58
    v_mov_b32 v62, s58
    v_mov_b32 v66, s58
    buffer_load_dwordx4 v[32:35], v24, s[28:31], s52 offen offset:0 sc1
    buffer_load_dwordx4 v[36:39], v24, s[28:31], s52 offen offset:256 sc1
    buffer_load_dwordx4 v[40:43], v24, s[28:31], s52 offen offset:512 sc1
    buffer_load_dwordx4 v[44:47], v24, s[28:31], s53 offen offset:0 sc1
    buffer_load_dwordx4 v[48:51], v24, s[28:31], s53 offen offset:256 sc1
    buffer_load_dwordx4 v[52:55], v24, s[28:31], s53 offen offset:512 sc1
    s_mov_b32 exec_hi, 0
    buffer_load_dwordx4 v[56:59], v24, s[28:31], s51 offen offset:0 sc1
    buffer_load_dwordx4 v[60:63], v24, s[28:31], s51 offen offset:256 sc1
    buffer_load_dwordx4 v[64:67], v24, s[28:31], s51 offen offset:512 sc1
    s_mov_b64 exec, -1
    s_waitcnt vmcnt(8)
    v_mfma_f32_16x16x16_bf16 v[72:75], v[16:17], v[32:33], 0
    s_waitcnt vmcnt(7)
    v_mfma_f32_16x16x16_bf16 v[72:75], v[18:19], v[36:37], v[72:75]
    s_waitcnt vmcnt(6)
    v_mfma_f32_16x16x16_bf16 v[72:75], v[20:21], v[40:41], v[72:75]
    s_waitcnt vmcnt(5)
    v_mfma_f32_16x16x16_bf16 v[72:75], v[16:17], v[44:45], v[72:75]
    s_waitcnt vmcnt(4)
    v_mfma_f32_16x16x16_bf16 v[72:75], v[18:19], v[48:49], v[72:75]
    s_waitcnt vmcnt(3)
    v_mfma_f32_16x16x16_bf16 v[72:75], v[20:21], v[52:53], v[72:75]
    s_waitcnt vmcnt(2)
    v_mfma_f32_16x16x16_bf16 v[72:75], v[16:17], v[56:57], v[72:75]
    s_waitcnt vmcnt(1)
    v_mfma_f32_16x16x16_bf16 v[72:75], v[18:19], v[60:61], v[72:75]
    s_waitcnt vmcnt(0)
    v_mfma_f32_16x16x16_bf16 v[72:75], v[20:21], v[64:65], v[72:75]
    v_cmpx_eq_u64 vcc, s[58:59], v[34:35]
    v_cmpx_eq_u64 vcc, s[58:59], v[38:39]
    v_cmpx_eq_u64 vcc, s[58:59], v[42:43]
    v_cmpx_eq_u64 vcc, s[58:59], v[46:47]
    v_cmpx_eq_u64 vcc, s[58:59], v[50:51]
    v_cmpx_eq_u64 vcc, s[58:59], v[54:55]
    v_cmpx_eq_u64 vcc, s[58:59], v[58:59]
    v_cmpx_eq_u64 vcc, s[58:59], v[62:63]
    v_cmpx_eq_u64 vcc, s[58:59], v[66:67]
    s_cmp_eq_u64 exec, -1
    s_mov_b64 exec, -1
    s_cbranch_scc1 OK_86
    v_or_b32 v34, 15, v34
    v_cmpx_eq_u64 vcc, s[48:49], v[34:35]
    v_or_b32 v38, 15, v38
    v_cmpx_eq_u64 vcc, s[48:49], v[38:39]
    v_or_b32 v42, 15, v42
    v_cmpx_eq_u64 vcc, s[48:49], v[42:43]
    v_or_b32 v46, 15, v46
    v_cmpx_eq_u64 vcc, s[48:49], v[46:47]
    v_or_b32 v50, 15, v50
    v_cmpx_eq_u64 vcc, s[48:49], v[50:51]
    v_or_b32 v54, 15, v54
    v_cmpx_eq_u64 vcc, s[48:49], v[54:55]
    v_or_b32 v58, 15, v58
    v_cmpx_eq_u64 vcc, s[48:49], v[58:59]
    v_or_b32 v62, 15, v62
    v_cmpx_eq_u64 vcc, s[48:49], v[62:63]
    v_or_b32 v66, 15, v66
    v_cmpx_eq_u64 vcc, s[48:49], v[66:67]
    s_cmp_eq_u64 exec, -1
    s_mov_b64 exec, -1
    s_cselect_b32 s60, 0, s42
    s_cselect_b32 s63, 1, 0
    s_and_b32 s60, s60, 15
    s_cbranch_scc1 GH_84
    s_branch SL_87
OK_86:
    v_lshlrev_b32 v8, 16, v22
    v_and_b32 v9, s54, v22
    v_lshlrev_b32 v10, 16, v23
    v_and_b32 v11, s54, v23
    s_mov_b32 s56, 3184710632
    v_mov_b32 v7, 0xc0135761
    v_add_f32 v72, v72, v8
    v_add_f32 v73, v73, v9
    v_add_f32 v74, v74, v10
    v_add_f32 v75, v75, v11
    v_mul_f32 v8, v72, v72
    v_mul_f32 v9, v73, v73
    v_mul_f32 v10, v74, v74
    v_mul_f32 v11, v75, v75
    v_fma_f32 v8, v8, s56, v7
    v_fma_f32 v9, v9, s56, v7
    v_fma_f32 v10, v10, s56, v7
    v_fma_f32 v11, v11, s56, v7
    v_mul_f32 v8, v8, v72
    v_mul_f32 v9, v9, v73
    v_mul_f32 v10, v10, v74
    v_mul_f32 v11, v11, v75
    v_exp_f32 v8, v8
    v_exp_f32 v9, v9
    v_exp_f32 v10, v10
    v_exp_f32 v11, v11
    v_add_f32 v8, 1.0, v8
    v_add_f32 v9, 1.0, v9
    v_add_f32 v10, 1.0, v10
    v_add_f32 v11, 1.0, v11
    v_rcp_f32 v8, v8
    v_rcp_f32 v9, v9
    v_rcp_f32 v10, v10
    v_rcp_f32 v11, v11
    v_mul_f32 v72, v72, v8
    v_mul_f32 v73, v73, v9
    v_mul_f32 v74, v74, v10
    v_mul_f32 v75, v75, v11
    s_mov_b32 exec_hi, 0xffff
    v_cvt_pk_bf16_f32 v72, v72, v73
    v_cvt_pk_bf16_f32 v73, v74, v75
    ds_write_b64 v26, v[72:73]
    s_mov_b64 exec, -1
    ds_add_u32 v1, v2 offset:2048
    s_branch L_ffn2
L_final:
    s_mov_b32 s40, s2
    v_and_b32 v6, 7, v0
    v_lshlrev_b32 v8, 3, v6
    v_bfe_u32 v7, v0, 4, 1
    v_lshl_add_u32 v8, v7, 2, v8
    v_lshrrev_b32 v7, 5, v0
    v_lshl_add_u32 v8, v7, 1, v8
    s_lshl_b32 s52, s40, 6
    s_mov_b32 s44, s4
    s_mov_b32 s45, s5
    s_mov_b32 s46, 1280
    s_mov_b32 s47, 0x20000
    s_mov_b32 s48, s24
    s_mov_b32 s49, s25
    s_mov_b32 s50, 1280
    s_mov_b32 s51, 0x20000
    buffer_load_ushort v10, v8, s[44:47], s52 offen
    buffer_load_ushort v11, v8, s[48:51], s52 offen
    v_lshrrev_b32 v7, 3, v0
    v_mul_u32_u24 v9, 2560, v7
    v_lshrrev_b32 v7, 2, v7
    v_mul_u32_u24 v7, 22528, v7
    v_add_u32 v7, v7, v9
    v_lshl_add_u32 v9, v6, 4, v7
    s_lshl_b32 s53, s40, 7
    s_add_u32 s56, s53, 2097152
    s_add_u32 s57, s56, 65536
    s_add_u32 s58, s57, 65536
    s_add_u32 s59, s58, 65536
    s_add_u32 s53, s53, 2359296
    s_waitcnt vmcnt(0)
    v_lshlrev_b32 v10, 16, v10
    v_lshlrev_b32 v11, 16, v11
    s_mov_b32 s44, s26
    s_mov_b32 s45, s27
    s_mov_b32 s46, 1280
    s_mov_b32 s47, 0x20000
WF_88:
    ds_read_b32 v3, v1 offset:1792
    s_waitcnt lgkmcnt(0)
    v_cmp_gt_u32 vcc, 1, v3
    s_cbranch_vccnz WF_88
    s_cmp_eq_u32 s40, 0
    s_cbranch_scc0 L_nep
    s_mov_b64 exec, 0xff
    v_mov_b32 v14, s32
    v_mov_b32 v15, s33
    v_lshlrev_b32 v6, 3, v0
    buffer_store_dwordx2 v[14:15], v6, s[28:31], 0 offen offset:0 sc1
    s_mov_b64 exec, -1
L_nep:
WF_89:
    ds_read_b32 v3, v1 offset:4096
    s_waitcnt lgkmcnt(0)
    v_cmp_gt_u32 vcc, 4, v3
    s_cbranch_vccnz WF_89
FS_90:
    s_sub_u32 s42, s42, 1
    s_cbranch_scc1 GU_91
    buffer_load_dwordx4 v[28:31], v9, s[28:31], s53 offen sc1
    buffer_load_dwordx4 v[12:15], v9, s[28:31], s56 offen sc1
    buffer_load_dwordx4 v[16:19], v9, s[28:31], s57 offen sc1
    buffer_load_dwordx4 v[20:23], v9, s[28:31], s58 offen sc1
    buffer_load_dwordx4 v[24:27], v9, s[28:31], s59 offen sc1
    s_waitcnt vmcnt(4)
    v_permlane32_swap_b32 v28, v29
    v_permlane32_swap_b32 v30, v31
    v_add_f32 v28, v28, v29
    v_add_f32 v30, v30, v31
    s_waitcnt vmcnt(2)
    v_pk_add_f32 v[12:13], v[12:13], v[16:17]
    v_permlane16_swap_b32 v28, v30
    v_add_f32 v28, v28, v30
    v_pk_add_f32 v[14:15], v[14:15], v[18:19]
    s_waitcnt vmcnt(0)
    v_add_f32_dpp v28, v28, v28 row_ror:8 row_mask:0xf bank_mask:0xf
    v_pk_add_f32 v[20:21], v[20:21], v[24:25]
    v_add_f32 v28, v28, v11
    v_pk_add_f32 v[22:23], v[22:23], v[26:27]
    v_mul_f32 v29, 0xbfb8aa3b, v28
    v_pk_add_f32 v[12:13], v[12:13], v[20:21]
    v_pk_add_f32 v[14:15], v[14:15], v[22:23]
    v_exp_f32 v29, v29
    v_permlane32_swap_b32 v12, v13
    v_permlane32_swap_b32 v14, v15
    v_add_f32 v12, v12, v13
    v_add_f32 v14, v14, v15
    v_add_f32 v29, 1.0, v29
    v_rcp_f32 v29, v29
    v_permlane16_swap_b32 v12, v14
    v_add_f32 v12, v12, v14
    v_mul_f32 v28, v28, v29
    s_nop 0
    v_add_f32_dpp v12, v12, v12 row_ror:8 row_mask:0xf bank_mask:0xf
    v_cmp_u_f32 vcc, v12, v28
    v_fma_f32 v13, v12, v28, v10
    s_cbranch_vccnz FS_90
OK_92:
    v_cvt_pk_bf16_f32 v13, v13, v13
    s_mov_b32 exec_lo, 0x00ff00ff
    s_mov_b32 exec_hi, 0x00ff00ff
    buffer_store_short v13, v8, s[44:47], s52 offen
L_fin:
    s_endpgm
GU_35:
    s_mov_b32 s42, 0
    s_mov_b64 exec, -1
    s_cmp_eq_u32 s53, 0
    s_nop 7
    s_branch OK_36
RM_38:
    s_nop 7
    buffer_store_dwordx4 v[168:171], v192, s[28:31], s9 offen sc1
    s_mov_b64 exec, 0xffff
    buffer_store_dword v8, v205, s[28:31], s10 offen sc1
    s_nop 1
    s_branch BK_39
GU_42:
    s_mov_b32 s42, 0
    s_mov_b64 exec, -1
    ds_add_u32 v1, v2 offset:2304
    s_nop 7
    s_branch OK_43
GW_44:
    ds_read_b32 v14, v1 offset:6912
    s_waitcnt lgkmcnt(0)
    v_cmp_ne_u32 vcc, 1, v14
    s_cbranch_vccnz GW_44
    s_nop 4
    s_branch GB_45
RM_48:
    s_nop 7
    buffer_store_dwordx4 v[176:179], v185, s[28:31], s16 offen offset:0 sc1
    s_nop 1
    s_branch BK_49
GU_56:
    s_mov_b32 s42, 0
    s_mov_b64 exec, -1
    s_nop 7
    s_branch OK_57
SL_58:
    s_mov_b32 exec_hi, 0xffff
    buffer_load_dwordx4 v[76:79], v28, s[28:31], s61 offen offset:3072 sc1
    s_waitcnt vmcnt(0)
    v_cmpx_eq_u64 vcc, s[58:59], v[78:79]
    s_cbranch_execz SL_58_n
    buffer_store_dwordx4 v[76:79], v28, s[28:31], s61 offen offset:3072 sc1
SL_58_n:
    s_mov_b64 exec, -1
    s_waitcnt vmcnt(0)
    s_cmp_eq_u32 s63, 0
    s_cbranch_scc1 GA_55
    v_mov_b32 v76, -1
    v_mov_b32 v77, -1
    v_mov_b32 v78, -1
    v_mov_b32 v79, -1
    v_mov_b32 v27, 3
    buffer_store_dwordx4 v[76:79], v28, s[28:31], s61 offen sc1
    buffer_store_dwordx4 v[76:79], v28, s[28:31], s61 offen offset:1024 sc1
    s_mov_b64 exec, 0xff
    buffer_store_dwordx4 v[76:79], v28, s[28:31], s61 offen offset:2048 sc1
    s_mov_b64 exec, -1
    s_waitcnt vmcnt(0)
    s_branch OK_57
GU_61:
    s_mov_b32 s42, 0
    s_mov_b64 exec, -1
    s_nop 7
    s_branch OK_62
GU_66:
    s_mov_b32 s42, 0
    s_mov_b64 exec, -1
    s_nop 7
    s_branch OK_67
GU_71:
    s_mov_b32 s42, 0
    s_mov_b64 exec, -1
    s_nop 7
    s_branch OK_72
GU_78:
    s_mov_b32 s42, 0
    s_mov_b64 exec, -1
    s_nop 7
    s_branch OK_79
GU_85:
    s_mov_b32 s42, 0
    s_mov_b64 exec, -1
    s_nop 7
    s_branch OK_86
SL_87:
    s_mov_b32 exec_hi, 0xffff
    buffer_load_dwordx4 v[76:79], v28, s[28:31], s61 offen offset:2304 sc1
    s_waitcnt vmcnt(0)
    v_cmpx_eq_u64 vcc, s[58:59], v[78:79]
    s_cbranch_execz SL_87_n
    buffer_store_dwordx4 v[76:79], v28, s[28:31], s61 offen offset:2304 sc1
SL_87_n:
    s_mov_b64 exec, -1
    s_waitcnt vmcnt(0)
    s_cmp_eq_u32 s63, 0
    s_cbranch_scc1 GH_84
    s_branch OK_86
GU_91:
    s_mov_b32 s42, 0
    s_mov_b64 exec, -1
    s_nop 7
    s_branch OK_92
L_end:
    s_endpgm
.section .rodata,"a"
.p2align 6
.amdhsa_kernel recurrent_scan__compressed_kv_cla__dense_activation_gelu__decode_kernel
  .amdhsa_next_free_vgpr 220
  .amdhsa_next_free_sgpr 100
  .amdhsa_accum_offset 220
  .amdhsa_group_segment_fixed_size 0
  .amdhsa_kernarg_size 112
  .amdhsa_user_sgpr_count 2
  .amdhsa_user_sgpr_kernarg_segment_ptr 1
  .amdhsa_system_sgpr_workgroup_id_x 1
.end_amdhsa_kernel
```
